```python
import torch

def _softmax(x, axis=-1):
    return torch.softmax(x, dim=axis)
def _gelu(x):
    return torch.nn.functional.gelu(x, approximate="tanh")
def _silu(x):
    return torch.nn.functional.silu(x)
def _sigmoid(x):
    return torch.sigmoid(x)
def _layernorm(x, axis=-1, eps=1e-5):
    m = x.mean(dim=axis, keepdim=True)
    v = x.var(dim=axis, keepdim=True, unbiased=False)
    return (x - m) / torch.sqrt(v + eps)
def _scatter_add(tgt, idx, src, axis=0):
    return tgt.clone().index_add_(axis, idx, src)
def _segment_sum(src, seg, n):
    out = torch.zeros((n,) + src.shape[1:], dtype=src.dtype)
    return out.index_add_(0, seg, src)
def _pad(x, pw):
    flat = tuple(v for pair in reversed(pw) for v in pair)
    return torch.nn.functional.pad(x, flat)

kernel_name = 'sequential_preLN__linear_attn_block__glu_gated_swiglu__prompt'

def setup_inputs():

    _w = (lambda a: (lambda t: t.to(torch.bfloat16) if t.is_floating_point() else t)(torch.as_tensor(a)))
    def _A_setup():
        B, S, D = 1, 2048, 512
        return {
            "x": _w((lambda *s: torch.randn(*s, dtype=torch.bfloat16) * 0.05)(B, S, D)),
            "wqkv": _w((lambda *s: torch.randn(*s, dtype=torch.bfloat16) * 0.05)(D, 3 * D)),
            "wo": _w((lambda *s: torch.randn(*s, dtype=torch.bfloat16) * 0.05)(D, D)),
        }
    _A_in = _A_setup()

    def _B_setup():
        B, S, D, F = 1, 2048, 512, 1792
        return {
            "x": _w((lambda *s: torch.randn(*s, dtype=torch.bfloat16) * 0.05)(B, S, D)),
            "w1": _w((lambda *s: torch.randn(*s, dtype=torch.bfloat16) * 0.2)(D, F) * (2.0 / D) ** 0.5),
            "w3": _w((lambda *s: torch.randn(*s, dtype=torch.bfloat16) * 0.2)(D, F) * (2.0 / D) ** 0.5),
            "w2": _w((lambda *s: torch.randn(*s, dtype=torch.bfloat16) * 0.2)(F, D) * (2.0 / F) ** 0.5),
        }
    _B_in = _B_setup()

    return {
        "A_x": _A_in["x"],
        "A_wqkv": _A_in["wqkv"],
        "A_wo": _A_in["wo"],
        "B_x": _B_in["x"],
        "B_w1": _B_in["w1"],
        "B_w3": _B_in["w3"],
        "B_w2": _B_in["w2"],
    }

def reference(A_x, A_wqkv, A_wo, B_x, B_w1, B_w3, B_w2):
    def _A_ref(x, wqkv, wo):
        B, S, D = x.shape
        H = 32; Dh = D // H
        qkv = (lambda x, *d: x.permute(*d))((x @ wqkv).reshape(B, S, 3, H, Dh), 2, 0, 3, 1, 4)
        q, k, v = qkv[0], qkv[1], qkv[2]
        phi = lambda t: torch.where(t > 0, t + 1, torch.exp(t)) + 1e-6
        pq, pk = phi(q), phi(k)
        kv = torch.einsum("bhsd,bhse->bhde", pk, v)
        z = torch.einsum("bhsd->bhd", pk)
        num = torch.einsum("bhqd,bhde->bhqe", pq, kv)
        den = torch.einsum("bhqd,bhd->bhq", pq, z)[..., None] + 1e-6
        o = num / den
        return (lambda x, *d: x.permute(*d))(o, 0, 2, 1, 3).reshape(B, S, D) @ wo

    def _B_ref(x, w1, w3, w2):
        gate = torch.einsum("bsd,df->bsf", x, w1)
        up = torch.einsum("bsd,df->bsf", x, w3)
        h = _silu(gate) * up
        out = torch.einsum("bsf,fd->bsd", h, w2)
        return out

    x = A_x
    h = x + _A_ref(_layernorm(x, axis=-1), A_wqkv, A_wo)
    h2 = h + _B_ref(_layernorm(h, axis=-1), B_w1, B_w3, B_w2)
    return h2
```

```asm
; @launch grid=(256,1,1) block=(256,1,1) lds=163840
.amdgcn_target "amdgcn-amd-amdhsa--gfx950"
.set CODE_PF_MAX, 28408
.text
.globl sequential_preLN__linear_attn_block__glu_gated_swiglu__prompt_kernel
.p2align 8
.type sequential_preLN__linear_attn_block__glu_gated_swiglu__prompt_kernel,@function
sequential_preLN__linear_attn_block__glu_gated_swiglu__prompt_kernel:
    s_cmp_ge_u32 s2, 256
    s_cbranch_scc1 L_end
    s_load_dwordx16 s[76:91], s[0:1], 0
    s_load_dwordx4 s[92:95], s[0:1], 64
    s_getpc_b64 s[70:71]
    s_lshr_b32 s3, s2, 3
    s_lshl_b32 s3, s3, 10
    v_lshrrev_b32 v200, 5, v0
    v_lshl_add_u32 v200, v200, 7, s3
    v_min_u32 v200, CODE_PF_MAX, v200
    global_load_dword v201, v200, s[70:71]
    s_mov_b32 s6, 0x200000
    s_mov_b32 s7, 0x20000
    s_mov_b32 s10, 0x180000
    s_mov_b32 s11, 0x20000
    s_lshr_b32 s56, s2, 3
    s_and_b32 s57, s2, 7
    s_and_b32 s54, s56, 3
    s_and_b32 s41, s2, 6
    s_lshl_b32 s41, s41, 1
    s_add_u32 s41, s41, s54
    s_lshr_b32 s45, s2, 5
    s_and_b32 s46, s45, 1
    s_lshl_b32 s74, s41, 1
    s_add_u32 s74, s74, s46
    v_and_b32 v1, 63, v0
    v_lshrrev_b32 v4, 6, v0
    s_nop 0
    v_readfirstlane_b32 s40, v4
    s_nop 0
    s_lshl_b32 s50, s40, 14
    s_lshl_b32 s48, s74, 16
    s_add_u32 s48, s48, s50
    s_and_b32 s47, s2, 1
    s_lshl_b32 s3, s47, 2
    s_lshr_b32 s44, s2, 6
    s_add_u32 s3, s3, s44
    s_mul_i32 s49, s40, 49152
    s_lshl_b32 s44, s3, 7
    s_add_u32 s49, s49, s44
    s_lshl_b32 s51, s40, 11
    s_and_b32 s43, s45, 6
    s_add_u32 s43, s43, s47
    s_lshr_b32 s44, s57, 1
    s_add_u32 s43, s43, s44
    s_lshl_b32 s44, s46, 2
    s_add_u32 s43, s43, s44
    v_lshrrev_b32 v4, 3, v1
    v_and_b32 v5, 7, v1
    v_lshrrev_b32 v3, 4, v1
    v_xor_b32 v6, v5, v3
    v_lshlrev_b32 v6, 4, v6
    v_lshl_add_u32 v6, v4, 10, v6
    v_xor_b32 v7, 64, v6
    v_add_u32 v7, 7168, v7
    v_and_b32 v3, 1, v3
    v_lshlrev_b32 v3, 2, v3
    v_xor_b32 v5, v5, v3
    v_lshlrev_b32 v5, 4, v5
    v_mul_u32_u24 v8, 3072, v4
    v_add_u32 v8, v8, v5
    v_add_u32 v9, 23552, v8
    s_waitcnt lgkmcnt(0)
    s_mov_b64 s[4:5], s[76:77]
    s_mov_b64 s[8:9], s[78:79]
    s_add_u32 s44, s43, 0
    s_and_b32 s44, s44, 7
    s_mul_i32 s75, s44, 196608
    s_add_u32 s75, s75, s49
    s_lshl_b32 s44, s44, 7
    s_add_u32 m0, s51, 97280
    s_nop 0
    buffer_load_dwordx4 v8, s[8:11], s75 offen offset:1024 lds
    buffer_load_dwordx4 v9, s[8:11], s75 offen offset:2048 lds
    s_add_u32 m0, s51, 0
    s_add_u32 s44, s44, s48
    buffer_load_dwordx4 v6, s[4:7], s44 offen lds
    buffer_load_dwordx4 v7, s[4:7], s44 offen offset:1024 lds
    s_add_u32 s44, s43, 1
    s_and_b32 s44, s44, 7
    s_mul_i32 s76, s44, 196608
    s_add_u32 s76, s76, s49
    s_lshl_b32 s44, s44, 7
    s_add_u32 m0, s51, 105472
    s_nop 0
    buffer_load_dwordx4 v8, s[8:11], s76 offen offset:1024 lds
    buffer_load_dwordx4 v9, s[8:11], s76 offen offset:2048 lds
    s_add_u32 m0, s51, 8192
    s_add_u32 s44, s44, s48
    buffer_load_dwordx4 v6, s[4:7], s44 offen lds
    buffer_load_dwordx4 v7, s[4:7], s44 offen offset:1024 lds
    s_lshl_b32 s68, s2, 2
    s_add_u32 s68, s68, s40
    s_lshr_b32 s58, s68, 1
    s_mul_i32 s58, s58, 3072
    s_and_b32 s59, s68, 1
    s_lshl_b32 s59, s59, 11
    s_add_u32 s58, s58, s59
    s_lshl_b32 s68, s68, 9
    v_lshlrev_b32 v2, 4, v1
    v_lshrrev_b32 v202, 3, v1
    v_lshlrev_b32 v202, 7, v202
    v_lshrrev_b32 v42, 4, v1
    v_lshlrev_b32 v42, 7, v42
    buffer_load_dword v203, v202, s[8:11], s58 offen
    s_mov_b64 s[12:13], s[80:81]
    s_mov_b32 s14, 0x80000
    s_mov_b32 s15, 0x20000
    s_mov_b64 s[16:17], s[84:85]
    s_mov_b32 s18, 0x1c0000
    s_mov_b32 s19, 0x20000
    s_mov_b64 s[20:21], s[86:87]
    s_mov_b32 s22, 0x1c0000
    s_mov_b32 s23, 0x20000
    s_mov_b64 s[24:25], s[88:89]
    s_mov_b32 s26, 0x1c0000
    s_mov_b32 s27, 0x20000
    s_mov_b64 s[28:29], s[90:91]
    s_mov_b32 s30, 0x200000
    s_mov_b32 s31, 0x20000
    s_mov_b64 s[36:37], s[92:93]
    s_mov_b32 s38, 0x100
    s_mov_b32 s39, 0x20000
    s_mov_b64 s[32:33], s[94:95]
    s_mov_b32 s34, 0x3400000
    s_mov_b32 s35, 0x20000
    s_lshl_b32 s67, s40, 8
    s_add_u32 s67, s67, 224
    s_cmp_lt_u32 s2, s67
    s_cbranch_scc1 L_z_1
    s_sub_u32 s46, s2, 224
    s_and_b32 s45, s56, 1
    s_lshl_b32 s47, s45, 5
    s_add_u32 s47, s47, s46
    s_lshl_b32 s47, s47, 8
    s_add_u32 s47, s47, 0x100000
    s_xor_b32 s58, s47, 0x2000
    s_waitcnt lgkmcnt(0)
    s_buffer_load_dword s69, s[32:35], s47 glc
    s_buffer_load_dword s69, s[32:35], s58 glc
    v_mov_b32 v16, 0
    v_mov_b32 v17, 0
    v_mov_b32 v18, 0
    v_mov_b32 v19, 0
    s_lshl_b32 s58, s46, 11
    s_lshl_b32 s47, s46, 12
    s_add_u32 s47, s47, 0x20000
    s_add_u32 s58, s58, 0x10000
    buffer_store_dwordx4 v[16:19], v2, s[32:35], s58 offen sc1
    buffer_store_dwordx4 v[16:19], v2, s[32:35], s58 offen offset:1024 sc1
    buffer_store_dwordx4 v[16:19], v2, s[32:35], s47 offen sc1
    buffer_store_dwordx4 v[16:19], v2, s[32:35], s47 offen offset:1024 sc1
    buffer_store_dwordx4 v[16:19], v2, s[32:35], s47 offen offset:2048 sc1
    buffer_store_dwordx4 v[16:19], v2, s[32:35], s47 offen offset:3072 sc1
L_z_1:
    s_mov_b32 s55, 0x3fb8aa3b
    s_mov_b32 s60, 0xffff0000
    s_mov_b32 s61, 0x358637bd
    s_mov_b32 s62, 0
    s_mov_b32 s63, -1
    s_mov_b32 s64, 0xffff0000
    s_mov_b32 s65, 0xffff0000
    s_mov_b32 s96, 0x22222222
    s_mov_b32 s97, 0x22222222
    s_mov_b32 s98, 0x44444444
    s_mov_b32 s99, 0x44444444
    s_mov_b32 s70, 0x88888888
    s_mov_b32 s71, 0x88888888
    s_and_b32 s42, s2, 1
    s_lshl_b32 s42, s42, 3
    s_lshr_b32 s45, s2, 5
    s_add_u32 s42, s42, s45
    s_lshr_b32 s53, s3, 1
    s_and_b32 s45, s40, 1
    s_lshr_b32 s46, s40, 1
    s_lshl_b32 s3, s3, 1
    s_add_u32 s3, s3, s46
    s_lshl_b32 s74, s74, 1
    s_add_u32 s74, s74, s45
    s_lshl_b32 s47, s45, 12
    s_lshl_b32 s58, s40, 5
    s_add_u32 s47, s47, s58
    v_lshl_add_u32 v239, v4, 10, v5
    v_mul_u32_u24 v4, 3584, v4
    v_add_u32 v237, v4, v5
    v_xor_b32 v238, 32, v237
    v_mov_b32 v4, 1
    v_lshlrev_b32 v3, 2, v1
    v_and_b32 v208, 31, v1
    v_lshrrev_b32 v209, 5, v1
    v_bfe_u32 v210, v1, 1, 3
    v_xor_b32 v210, v209, v210
    v_lshlrev_b32 v210, 4, v210
    v_lshl_add_u32 v210, v208, 7, v210
    v_xor_b32 v10, s47, v210
    v_xor_b32 v11, 32, v10
    v_xor_b32 v12, 64, v10
    v_xor_b32 v13, 96, v10
    s_lshl_b32 s47, s53, 1
    s_add_u32 s47, s47, s46
    s_sub_u32 s47, s47, s43
    s_and_b32 s47, s47, 7
    s_lshl_b32 s47, s47, 1
    s_bfe_u32 s58, s2, 0x10006
    s_add_u32 s47, s47, s58
    s_lshl_b32 s47, s47, 6
    s_add_u32 s47, s47, s45
    s_lshl_b32 s47, s47, 6
    v_xor_b32 v14, s47, v210
    v_xor_b32 v15, 32, v14
    s_lshl_b32 s47, s46, 8
    s_add_u32 s47, s47, 0x20000
    v_lshl_add_u32 v213, v208, 3, s47
    s_lshl_b32 s47, s45, 2
    v_add_u32 v212, s47, v213
    s_lshl_b32 s47, s40, 9
    s_add_u32 s47, s47, 0x20800
    v_lshl_add_u32 v216, v1, 3, s47
    v_xor_b32 v220, 1024, v216
    v_lshlrev_b32 v214, 4, v208
    v_lshl_add_u32 v214, v209, 10, v214
    s_add_u32 s47, s51, 0x0
    v_add_u32 v214, s47, v214
    s_lshl_b32 s47, s40, 7
    s_add_u32 s47, s47, 0x21000
    v_lshl_add_u32 v215, v208, 2, s47
    s_lshl_b32 s47, s46, 2
    s_add_u32 s47, s47, s45
    s_lshl_b32 s58, s47, 10
    s_add_u32 s58, s58, 0x0
    v_add_u32 v217, s58, v3
    s_lshl_b32 s58, s47, 6
    s_add_u32 s58, s58, 0x21000
    s_lshl_b32 s47, s3, 1
    s_add_u32 s47, s47, s45
    s_lshl_b32 s84, s47, 10
    s_add_u32 s84, s84, 0x10000
    s_lshl_b32 s85, s47, 6
    s_add_u32 s85, s85, 0x1f800
    s_lshl_b32 s86, s74, 2
    s_lshr_b32 s47, s3, 2
    s_add_u32 s86, s86, s47
    s_lshl_b32 s86, s86, 3
    s_and_b32 s47, s3, 3
    s_add_u32 s86, s86, s47
    s_lshl_b32 s86, s86, 11
    s_add_u32 s86, s86, 0x400000
    s_lshl_b32 s83, s41, 2
    s_add_u32 s83, s83, s40
    s_lshl_b32 s83, s83, 4
    s_add_u32 s83, s83, s42
    s_lshl_b32 s83, s83, 14
    s_add_u32 s83, s83, 0x1001000
    s_lshl_b32 s47, s46, 6
    s_add_u32 s47, s47, s51
    v_and_b32 v211, 15, v1
    v_lshl_add_u32 v218, v211, 2, s58
    v_lshrrev_b32 v211, 4, v1
    v_lshl_add_u32 v219, v211, 27, v3
    v_lshl_add_u32 v243, v209, 27, v3
    v_lshrrev_b32 v246, 3, v1
    v_lshlrev_b32 v246, 27, v246
    v_min_u32 v245, 1, v1
    v_lshlrev_b32 v245, 27, v245
    v_bfe_u32 v210, v1, 2, 2
    v_lshlrev_b32 v208, 10, v209
    v_lshl_add_u32 v208, v210, 7, v208
    v_bfe_u32 v210, v1, 4, 1
    v_bfe_u32 v211, v1, 3, 1
    v_lshl_add_u32 v211, v211, 1, v210
    v_lshl_add_u32 v208, v211, 5, v208
    v_and_b32 v211, 1, v1
    v_lshl_add_u32 v241, v211, 4, v208
    v_bfe_u32 v211, v1, 1, 1
    v_lshl_add_u32 v241, v211, 3, v241
    v_and_b32 v211, 3, v1
    v_lshl_add_u32 v208, v211, 3, v208
    s_add_u32 s58, s47, 0x18000
    v_xor_b32 v152, s58, v208
    s_add_u32 s58, s47, 0x10000
    s_lshl_b32 s47, s40, 5
    s_add_u32 s47, s47, 0x22000
    s_mul_i32 s95, s40, 6144
    s_add_u32 s95, s95, 0x22000
    s_lshl_b32 s66, s54, 17
    s_add_u32 s66, s66, s50
    v_xor_b32 v156, s58, v241
    v_xor_b32 v153, 2048, v152
    v_xor_b32 v157, 2048, v156
    v_xor_b32 v154, 4096, v152
    v_xor_b32 v158, 4096, v156
    v_xor_b32 v155, 6144, v152
    v_xor_b32 v159, 6144, v156
    v_xor_b32 v240, s47, v208
    v_lshl_add_u32 v240, v210, 11, v240
    v_add_u32 v241, s95, v208
    v_xor_b32 v242, 64, v241
    v_lshrrev_b32 v208, 2, v1
    v_xor_b32 v208, v208, v210
    v_and_b32 v208, 1, v208
    v_or_b32 v208, v208, v211
    v_cmp_eq_u32 vcc, 0, v208
    v_mov_b32 v20, 0x3f803f80
    v_mov_b32 v21, 0x3f803f80
    v_mov_b32 v22, 0x3f803f80
    v_mov_b32 v23, 0x3f803f80
    v_cndmask_b32 v16, 0, v20, vcc
    v_cndmask_b32 v17, 0, v20, vcc
    v_cndmask_b32 v18, 0, v20, vcc
    v_cndmask_b32 v19, 0, v20, vcc
    v_mov_b32 v162, 0
    v_mov_b32 v163, 0
    v_mov_b32 v166, 0
    v_mov_b32 v167, 0
    v_mov_b32 v170, 0
    v_mov_b32 v171, 0
    v_mov_b32 v174, 0
    v_mov_b32 v175, 0
    v_mov_b32 v177, 0
    v_mov_b32 v178, 0
    v_mov_b32 v179, 0
    v_lshrrev_b32 v208, 4, v1
    v_bfe_u32 v210, v1, 2, 2
    v_xor_b32 v210, v210, v208
    v_lshlrev_b32 v210, 6, v210
    v_lshl_add_u32 v210, v208, 10, v210
    v_lshl_add_u32 v221, v211, 4, v210
    v_add_u32 v222, 3072, v221
    v_add_u32 v223, 6144, v221
    v_add_u32 v224, 9216, v221
    s_lshl_b32 s47, s53, 8
    s_add_u32 s66, s66, s47
    s_lshl_b32 s47, s57, 2
    s_add_u32 s47, s47, s40
    s_mul_i32 s90, s47, 57344
    s_lshl_b32 s47, s56, 7
    s_add_u32 s90, s90, s47
    s_lshl_b32 s46, s56, 2
    s_add_u32 s46, s46, s40
    s_lshl_b32 s92, s46, 14
    s_lshl_b32 s47, s57, 7
    s_add_u32 s92, s92, s47
    s_add_u32 s94, s92, 7168
    s_lshl_b32 s89, s46, 7
    s_add_u32 s89, s89, 0x1c000
    s_mul_i32 s47, s46, 9363
    s_lshr_b32 s47, s47, 16
    s_add_u32 s46, s46, s47
    s_and_b32 s47, s57, 6
    s_add_u32 s47, s47, s57
    s_lshl_b32 s87, s46, 4
    s_add_u32 s87, s87, s47
    s_lshl_b32 s87, s87, 12
    s_add_u32 s87, s87, 0x2000000
    s_andn2_b32 s47, s46, 3
    s_add_u32 s47, s47, s46
    s_lshl_b32 s88, s57, 8
    s_add_u32 s88, s88, s47
    s_lshl_b32 s88, s88, 11
    s_add_u32 s88, s88, 0x2800000
    s_and_b32 s47, s46, 15
    s_lshr_b32 s47, 0x33cc, s47
    s_lshr_b32 s58, 0x57575050, s46
    s_xor_b32 s58, s58, s57
    s_and_b32 s47, s47, 1
    s_lshl_b32 s47, s47, 13
    s_add_u32 s87, s87, s47
    s_and_b32 s58, s58, 0
    s_lshl_b32 s58, s58, 13
    s_add_u32 s88, s88, s58
    s_cmp_ge_u32 s2, 224
    s_cselect_b32 s87, 0x7f000000, s87
    s_cselect_b32 s88, 0x7f000000, s88
    s_cselect_b32 s89, 0x7f000000, s89
    s_cselect_b32 s90, 0x7f000000, s90
    s_and_b32 s47, s46, 7
    s_cmp_ge_u32 s47, 4
    s_cselect_b32 s1, s87, 0x7f000000
    s_cselect_b32 s87, 0x7f000000, s87
    s_add_u32 s91, s90, 27648
    s_and_b32 s93, s56, 15
    s_lshl_b32 s93, s93, 8
    s_add_u32 s93, s93, 0x20000
    s_cmp_eq_u32 s40, 0
    s_cselect_b32 s93, s93, 0x7f000000
    s_cmp_lt_u32 s2, s67
    s_cbranch_scc1 L_z_2
    s_sub_u32 s46, s2, 224
    s_and_b32 s45, s56, 1
    s_lshl_b32 s47, s45, 5
    s_add_u32 s47, s47, s46
    s_lshl_b32 s47, s47, 8
    s_add_u32 s47, s47, 0x100000
    s_xor_b32 s58, s47, 0x2000
    s_waitcnt lgkmcnt(0)
    s_buffer_load_dword s59, s[32:35], s47 glc
    s_buffer_load_dword s59, s[32:35], s58 glc
    s_getreg_b32 s58, hwreg(HW_REG_XCC_ID, 2, 1)
    s_waitcnt lgkmcnt(1)
    s_nop 15
    s_getreg_b32 s46, hwreg(HW_REG_IB_STS, 8, 4)
    s_waitcnt lgkmcnt(0)
    s_min_u32 s46, s46, 1
    s_xor_b32 s45, s45, s58
    s_cmp_lg_u32 s45, s46
    s_cselect_b32 s46, 64, 4096
    s_add_u32 s46, s46, 1
    s_add_u32 s59, s57, 18
    s_lshl_b32 s58, s58, s59
    s_cmp_eq_u32 s56, 28
    s_cselect_b32 s58, s58, 0
    s_add_u32 s46, s46, s58
    v_mov_b32 v46, s46
L_z_2:
    s_add_u32 s44, s43, 2
    s_and_b32 s44, s44, 7
    s_mul_i32 s77, s44, 196608
    s_add_u32 s77, s77, s49
    s_lshl_b32 s44, s44, 7
    s_add_u32 m0, s51, 113664
    s_nop 0
    buffer_load_dwordx4 v8, s[8:11], s77 offen offset:1024 lds
    buffer_load_dwordx4 v9, s[8:11], s77 offen offset:2048 lds
    s_add_u32 m0, s51, 16384
    s_add_u32 s44, s44, s48
    buffer_load_dwordx4 v6, s[4:7], s44 offen lds
    buffer_load_dwordx4 v7, s[4:7], s44 offen offset:1024 lds
    s_waitcnt vmcnt(9)
    s_barrier
    ds_read_b128 a[0:3], v10 offset:0
    ds_read_b64_tr_b16 v[128:129], v152 offset:0
    ds_read_b64_tr_b16 v[130:131], v152 offset:512
    ds_read_b128 a[4:7], v11 offset:0
    ds_read_b64_tr_b16 v[132:133], v153 offset:0
    ds_read_b64_tr_b16 v[134:135], v153 offset:512
    s_waitcnt lgkmcnt(3)
    v_mfma_f32_32x32x16_bf16 v[48:63], a[0:3], v[128:131], 0
    ds_read_b128 a[8:11], v12 offset:0
    ds_read_b64_tr_b16 v[136:137], v154 offset:0
    ds_read_b64_tr_b16 v[138:139], v154 offset:512
    v_lshrrev_b32 v209, 5, v1
    v_and_b32 v208, 31, v1
    v_mfma_f32_16x16x32_bf16 v[36:39], v[16:19], v[128:131], 0
    v_lshlrev_b32 v233, 10, v208
    v_mfma_f32_16x16x32_bf16 v[252:255], v[16:19], a[0:3], 0
    v_lshl_add_u32 v233, v209, 4, v233
    v_mfma_f32_4x4x4_16b_bf16 v[248:251], a[0:1], a[0:1], 0
    v_bfe_u32 v210, v1, 2, 2
    v_mfma_f32_4x4x4_16b_bf16 v[32:35], a[2:3], a[2:3], 0
    s_waitcnt lgkmcnt(3)
    v_mfma_f32_32x32x16_bf16 v[48:63], a[4:7], v[132:135], v[48:63]
    ds_read_b128 a[12:15], v13 offset:0
    ds_read_b64_tr_b16 v[140:141], v155 offset:0
    ds_read_b64_tr_b16 v[142:143], v155 offset:512
    v_and_b32 v208, 1, v1
    v_lshlrev_b32 v208, 4, v208
    v_mfma_f32_16x16x32_bf16 v[252:255], v[16:19], a[4:7], v[252:255]
    v_bfe_u32 v211, v1, 1, 1
    v_mfma_f32_4x4x4_16b_bf16 v[248:251], a[4:5], a[4:5], v[248:251]
    v_lshl_add_u32 v208, v211, 3, v208
    v_mfma_f32_4x4x4_16b_bf16 v[32:35], a[6:7], a[6:7], v[32:35]
    s_waitcnt lgkmcnt(3)
    v_mfma_f32_32x32x16_bf16 v[48:63], a[8:11], v[136:139], v[48:63]
    s_waitcnt vmcnt(5)
    s_barrier
    ds_read_b128 a[16:19], v10 offset:8192
    ds_read_b64_tr_b16 v[144:145], v152 offset:8192
    ds_read_b64_tr_b16 v[146:147], v152 offset:8704
    s_add_u32 s44, s43, 3
    s_and_b32 s44, s44, 7
    s_mul_i32 s78, s44, 196608
    s_add_u32 s78, s78, s49
    s_lshl_b32 s44, s44, 7
    s_add_u32 m0, s51, 121856
    s_nop 0
    buffer_load_dwordx4 v8, s[8:11], s78 offen offset:1024 lds
    v_mfma_f32_16x16x32_bf16 v[36:39], v[16:19], v[136:139], v[36:39]
    v_lshl_add_u32 v211, v209, 11, v208
    s_waitcnt lgkmcnt(3)
    v_mfma_f32_32x32x16_bf16 v[48:63], a[12:15], v[140:143], v[48:63]
    ds_read_b128 a[20:23], v11 offset:8192
    ds_read_b64_tr_b16 v[148:149], v153 offset:8192
    ds_read_b64_tr_b16 v[150:151], v153 offset:8704
    buffer_load_dwordx4 v9, s[8:11], s78 offen offset:2048 lds
    v_lshl_add_u32 v211, v210, 8, v211
    v_xor_b32 v210, s40, v210
    s_waitcnt lgkmcnt(3)
    v_mfma_f32_32x32x16_bf16 v[48:63], a[16:19], v[144:147], v[48:63]
    ds_read_b128 a[24:27], v12 offset:8192
    ds_read_b64_tr_b16 v[128:129], v154 offset:8192
    ds_read_b64_tr_b16 v[130:131], v154 offset:8704
    s_add_u32 m0, s51, 24576
    s_add_u32 s44, s44, s48
    buffer_load_dwordx4 v6, s[4:7], s44 offen lds
    v_mfma_f32_16x16x32_bf16 v[36:39], v[16:19], v[144:147], v[36:39]
    v_lshl_add_u32 v211, v210, 6, v211
    v_mfma_f32_16x16x32_bf16 v[252:255], v[16:19], a[16:19], v[252:255]
    v_bfe_u32 v210, v1, 4, 1
    v_mfma_f32_4x4x4_16b_bf16 v[248:251], a[16:17], a[16:17], v[248:251]
    v_lshl_add_u32 v211, v210, 5, v211
    v_mfma_f32_4x4x4_16b_bf16 v[32:35], a[18:19], a[18:19], v[32:35]
    s_waitcnt lgkmcnt(3)
    v_mfma_f32_32x32x16_bf16 v[48:63], a[20:23], v[148:151], v[48:63]
    ds_read_b128 a[28:31], v13 offset:8192
    ds_read_b64_tr_b16 v[132:133], v155 offset:8192
    ds_read_b64_tr_b16 v[134:135], v155 offset:8704
    buffer_load_dwordx4 v7, s[4:7], s44 offen offset:1024 lds
    v_mfma_f32_16x16x32_bf16 v[252:255], v[16:19], a[20:23], v[252:255]
    v_mfma_f32_4x4x4_16b_bf16 v[248:251], a[20:21], a[20:21], v[248:251]
    v_mfma_f32_4x4x4_16b_bf16 v[32:35], a[22:23], a[22:23], v[32:35]
    s_xor_b32 s46, s40, 0
    s_lshl_b32 s47, s46, 14
    v_add_u32 v225, s47, v211
    s_waitcnt lgkmcnt(3)
    v_mfma_f32_32x32x16_bf16 v[48:63], a[24:27], v[128:131], v[48:63]
    s_waitcnt vmcnt(4)
    s_barrier
    s_cmp_ge_u32 s2, s67
    s_cbranch_scc1 L_o_3
L_r_4:
    ds_read_b128 a[32:35], v10 offset:16384
    ds_read_b64_tr_b16 v[136:137], v152 offset:16384
    ds_read_b64_tr_b16 v[138:139], v152 offset:16896
    s_add_u32 s44, s43, 4
    s_and_b32 s44, s44, 7
    s_mul_i32 s79, s44, 196608
    s_add_u32 s79, s79, s49
    s_lshl_b32 s44, s44, 7
    s_add_u32 m0, s51, 130048
    s_nop 0
    buffer_load_dwordx4 v8, s[8:11], s79 offen offset:1024 lds
    v_mfma_f32_16x16x32_bf16 v[36:39], v[16:19], v[128:131], v[36:39]
    s_lshl_b32 s46, s46, 12
    s_add_u32 s46, s46, 0x20000
    v_add_u32 v229, s46, v2
    s_waitcnt lgkmcnt(3)
    v_mfma_f32_32x32x16_bf16 v[48:63], a[28:31], v[132:135], v[48:63]
    ds_read_b128 a[36:39], v11 offset:16384
    ds_read_b64_tr_b16 v[140:141], v153 offset:16384
    ds_read_b64_tr_b16 v[142:143], v153 offset:16896
    buffer_load_dwordx4 v9, s[8:11], s79 offen offset:2048 lds
    s_xor_b32 s46, s40, 1
    s_lshl_b32 s47, s46, 14
    v_add_u32 v226, s47, v211
    s_waitcnt lgkmcnt(3)
    v_mfma_f32_32x32x16_bf16 v[48:63], a[32:35], v[136:139], v[48:63]
    ds_read_b128 a[40:43], v12 offset:16384
    ds_read_b64_tr_b16 v[144:145], v154 offset:16384
    ds_read_b64_tr_b16 v[146:147], v154 offset:16896
    s_add_u32 m0, s51, 32768
    s_add_u32 s44, s44, s48
    buffer_load_dwordx4 v6, s[4:7], s44 offen lds
    v_mfma_f32_16x16x32_bf16 v[36:39], v[16:19], v[136:139], v[36:39]
    v_mfma_f32_16x16x32_bf16 v[252:255], v[16:19], a[32:35], v[252:255]
    v_mfma_f32_4x4x4_16b_bf16 v[248:251], a[32:33], a[32:33], v[248:251]
    v_mfma_f32_4x4x4_16b_bf16 v[32:35], a[34:35], a[34:35], v[32:35]
    s_lshl_b32 s46, s46, 12
    s_add_u32 s46, s46, 0x20000
    v_add_u32 v230, s46, v2
    s_waitcnt lgkmcnt(3)
    v_mfma_f32_32x32x16_bf16 v[48:63], a[36:39], v[140:143], v[48:63]
    ds_read_b128 a[44:47], v13 offset:16384
    ds_read_b64_tr_b16 v[148:149], v155 offset:16384
    ds_read_b64_tr_b16 v[150:151], v155 offset:16896
    buffer_load_dwordx4 v7, s[4:7], s44 offen offset:1024 lds
    v_mfma_f32_16x16x32_bf16 v[252:255], v[16:19], a[36:39], v[252:255]
    v_mfma_f32_4x4x4_16b_bf16 v[248:251], a[36:37], a[36:37], v[248:251]
    v_mfma_f32_4x4x4_16b_bf16 v[32:35], a[38:39], a[38:39], v[32:35]
    s_xor_b32 s46, s40, 2
    s_lshl_b32 s47, s46, 14
    v_add_u32 v227, s47, v211
    s_waitcnt lgkmcnt(3)
    v_mfma_f32_32x32x16_bf16 v[48:63], a[40:43], v[144:147], v[48:63]
    s_waitcnt vmcnt(4)
    s_barrier
    ds_read_b128 a[48:51], v10 offset:24576
    ds_read_b64_tr_b16 v[128:129], v152 offset:24576
    ds_read_b64_tr_b16 v[130:131], v152 offset:25088
    s_add_u32 s44, s43, 5
    s_and_b32 s44, s44, 7
    s_mul_i32 s80, s44, 196608
    s_add_u32 s80, s80, s49
    s_lshl_b32 s44, s44, 7
    s_add_u32 m0, s51, 138240
    s_nop 0
    buffer_load_dwordx4 v8, s[8:11], s80 offen offset:1024 lds
    v_mfma_f32_16x16x32_bf16 v[36:39], v[16:19], v[144:147], v[36:39]
    s_lshl_b32 s46, s46, 12
    s_add_u32 s46, s46, 0x20000
    v_add_u32 v231, s46, v2
    s_waitcnt lgkmcnt(3)
    v_mfma_f32_32x32x16_bf16 v[48:63], a[44:47], v[148:151], v[48:63]
    ds_read_b128 a[52:55], v11 offset:24576
    ds_read_b64_tr_b16 v[132:133], v153 offset:24576
    ds_read_b64_tr_b16 v[134:135], v153 offset:25088
    buffer_load_dwordx4 v9, s[8:11], s80 offen offset:2048 lds
    s_xor_b32 s46, s40, 3
    s_lshl_b32 s47, s46, 14
    v_add_u32 v228, s47, v211
    s_waitcnt lgkmcnt(3)
    v_mfma_f32_32x32x16_bf16 v[48:63], a[48:51], v[128:131], v[48:63]
    ds_read_b128 a[56:59], v12 offset:24576
    ds_read_b64_tr_b16 v[136:137], v154 offset:24576
    ds_read_b64_tr_b16 v[138:139], v154 offset:25088
    s_add_u32 m0, s51, 40960
    s_add_u32 s44, s44, s48
    buffer_load_dwordx4 v6, s[4:7], s44 offen lds
    v_mfma_f32_16x16x32_bf16 v[36:39], v[16:19], v[128:131], v[36:39]
    v_xor_b32 v211, 1, v210
    v_mfma_f32_16x16x32_bf16 v[252:255], v[16:19], a[48:51], v[252:255]
    v_lshlrev_b32 v211, 5, v211
    v_mfma_f32_4x4x4_16b_bf16 v[248:251], a[48:49], a[48:49], v[248:251]
    v_lshl_add_u32 v211, v209, 4, v211
    v_mfma_f32_4x4x4_16b_bf16 v[32:35], a[50:51], a[50:51], v[32:35]
    s_lshl_b32 s46, s46, 12
    s_add_u32 s46, s46, 0x20000
    v_add_u32 v232, s46, v2
    s_waitcnt lgkmcnt(3)
    v_mfma_f32_32x32x16_bf16 v[48:63], a[52:55], v[132:135], v[48:63]
    ds_read_b128 a[60:63], v13 offset:24576
    ds_read_b64_tr_b16 v[140:141], v155 offset:24576
    ds_read_b64_tr_b16 v[142:143], v155 offset:25088
    buffer_load_dwordx4 v7, s[4:7], s44 offen offset:1024 lds
    v_lshlrev_b32 v236, 8, v1
    v_mfma_f32_16x16x32_bf16 v[252:255], v[16:19], a[52:55], v[252:255]
    v_mfma_f32_4x4x4_16b_bf16 v[248:251], a[52:53], a[52:53], v[248:251]
    v_mfma_f32_4x4x4_16b_bf16 v[32:35], a[54:55], a[54:55], v[32:35]
    s_lshl_b32 s46, s40, 12
    s_add_u32 s46, s46, 150528
    v_add_u32 v234, s46, v3
    s_waitcnt lgkmcnt(3)
    v_mfma_f32_32x32x16_bf16 v[48:63], a[56:59], v[136:139], v[48:63]
    s_waitcnt vmcnt(4)
    s_barrier
    ds_read_b128 a[64:67], v10 offset:32768
    ds_read_b64_tr_b16 v[144:145], v152 offset:32768
    ds_read_b64_tr_b16 v[146:147], v152 offset:33280
    s_add_u32 s44, s43, 6
    s_and_b32 s44, s44, 7
    s_mul_i32 s81, s44, 196608
    s_add_u32 s81, s81, s49
    s_lshl_b32 s44, s44, 7
    s_add_u32 m0, s51, 146432
    s_nop 0
    buffer_load_dwordx4 v8, s[8:11], s81 offen offset:1024 lds
    v_mfma_f32_16x16x32_bf16 v[36:39], v[16:19], v[136:139], v[36:39]
    v_add_u32 v235, s46, v211
    s_waitcnt lgkmcnt(3)
    v_mfma_f32_32x32x16_bf16 v[48:63], a[60:63], v[140:143], v[48:63]
    ds_read_b128 a[68:71], v11 offset:32768
    ds_read_b64_tr_b16 v[148:149], v153 offset:32768
    ds_read_b64_tr_b16 v[150:151], v153 offset:33280
    buffer_load_dwordx4 v9, s[8:11], s81 offen offset:2048 lds
    v_lshrrev_b32 v211, 4, v1
    s_waitcnt lgkmcnt(3)
    v_mfma_f32_32x32x16_bf16 v[48:63], a[64:67], v[144:147], v[48:63]
    ds_read_b128 a[72:75], v12 offset:32768
    ds_read_b64_tr_b16 v[128:129], v154 offset:32768
    ds_read_b64_tr_b16 v[130:131], v154 offset:33280
    s_add_u32 m0, s51, 49152
    s_add_u32 s44, s44, s48
    buffer_load_dwordx4 v6, s[4:7], s44 offen lds
    v_mfma_f32_16x16x32_bf16 v[36:39], v[16:19], v[144:147], v[36:39]
    v_lshl_add_u32 v236, v211, 27, v236
    v_mfma_f32_16x16x32_bf16 v[252:255], v[16:19], a[64:67], v[252:255]
    v_mfma_f32_4x4x4_16b_bf16 v[248:251], a[64:65], a[64:65], v[248:251]
    v_mfma_f32_4x4x4_16b_bf16 v[32:35], a[66:67], a[66:67], v[32:35]
    s_waitcnt lgkmcnt(3)
    v_mfma_f32_32x32x16_bf16 v[48:63], a[68:71], v[148:151], v[48:63]
    ds_read_b128 a[76:79], v13 offset:32768
    ds_read_b64_tr_b16 v[132:133], v155 offset:32768
    ds_read_b64_tr_b16 v[134:135], v155 offset:33280
    buffer_load_dwordx4 v7, s[4:7], s44 offen offset:1024 lds
    v_mfma_f32_16x16x32_bf16 v[252:255], v[16:19], a[68:71], v[252:255]
    v_mfma_f32_4x4x4_16b_bf16 v[248:251], a[68:69], a[68:69], v[248:251]
    v_mfma_f32_4x4x4_16b_bf16 v[32:35], a[70:71], a[70:71], v[32:35]
    s_waitcnt lgkmcnt(3)
    v_mfma_f32_32x32x16_bf16 v[48:63], a[72:75], v[128:131], v[48:63]
    s_waitcnt vmcnt(4)
    s_barrier
    ds_read_b128 a[80:83], v10 offset:40960
    ds_read_b64_tr_b16 v[136:137], v152 offset:40960
    ds_read_b64_tr_b16 v[138:139], v152 offset:41472
    s_add_u32 s44, s43, 7
    s_and_b32 s44, s44, 7
    s_mul_i32 s82, s44, 196608
    s_add_u32 s82, s82, s49
    s_lshl_b32 s44, s44, 7
    s_add_u32 m0, s51, 154624
    s_nop 0
    buffer_load_dwordx4 v8, s[8:11], s82 offen offset:1024 lds
    v_mfma_f32_16x16x32_bf16 v[36:39], v[16:19], v[128:131], v[36:39]
    s_waitcnt lgkmcnt(3)
    v_mfma_f32_32x32x16_bf16 v[48:63], a[76:79], v[132:135], v[48:63]
    ds_read_b128 a[84:87], v11 offset:40960
    ds_read_b64_tr_b16 v[140:141], v153 offset:40960
    ds_read_b64_tr_b16 v[142:143], v153 offset:41472
    buffer_load_dwordx4 v9, s[8:11], s82 offen offset:2048 lds
    s_waitcnt lgkmcnt(3)
    v_mfma_f32_32x32x16_bf16 v[48:63], a[80:83], v[136:139], v[48:63]
    ds_read_b128 a[88:91], v12 offset:40960
    ds_read_b64_tr_b16 v[144:145], v154 offset:40960
    ds_read_b64_tr_b16 v[146:147], v154 offset:41472
    s_add_u32 m0, s51, 57344
    s_add_u32 s44, s44, s48
    buffer_load_dwordx4 v6, s[4:7], s44 offen lds
    v_mfma_f32_16x16x32_bf16 v[36:39], v[16:19], v[136:139], v[36:39]
    v_mfma_f32_16x16x32_bf16 v[252:255], v[16:19], a[80:83], v[252:255]
    v_mfma_f32_4x4x4_16b_bf16 v[248:251], a[80:81], a[80:81], v[248:251]
    v_mfma_f32_4x4x4_16b_bf16 v[32:35], a[82:83], a[82:83], v[32:35]
    s_waitcnt lgkmcnt(3)
    v_mfma_f32_32x32x16_bf16 v[48:63], a[84:87], v[140:143], v[48:63]
    ds_read_b128 a[92:95], v13 offset:40960
    ds_read_b64_tr_b16 v[148:149], v155 offset:40960
    ds_read_b64_tr_b16 v[150:151], v155 offset:41472
    buffer_load_dwordx4 v7, s[4:7], s44 offen offset:1024 lds
    v_mfma_f32_16x16x32_bf16 v[252:255], v[16:19], a[84:87], v[252:255]
    v_mfma_f32_4x4x4_16b_bf16 v[248:251], a[84:85], a[84:85], v[248:251]
    v_mfma_f32_4x4x4_16b_bf16 v[32:35], a[86:87], a[86:87], v[32:35]
    s_waitcnt lgkmcnt(3)
    v_mfma_f32_32x32x16_bf16 v[48:63], a[88:91], v[144:147], v[48:63]
    s_waitcnt vmcnt(4)
    s_barrier
    ds_read_b128 a[96:99], v10 offset:49152
    ds_read_b64_tr_b16 v[128:129], v152 offset:49152
    s_add_u32 m0, s51, 63488
    ds_read_b64_tr_b16 v[130:131], v152 offset:49664
    buffer_load_dwordx4 v8, s[8:11], s75 offen offset:2048 lds
    v_mfma_f32_16x16x32_bf16 v[36:39], v[16:19], v[144:147], v[36:39]
    s_waitcnt lgkmcnt(3)
    v_mfma_f32_32x32x16_bf16 v[48:63], a[92:95], v[148:151], v[48:63]
    ds_read_b128 a[100:103], v11 offset:49152
    ds_read_b64_tr_b16 v[132:133], v153 offset:49152
    ds_read_b64_tr_b16 v[134:135], v153 offset:49664
    buffer_load_dwordx4 v9, s[8:11], s75 offen offset:3072 lds
    s_waitcnt lgkmcnt(3)
    v_mfma_f32_32x32x16_bf16 v[48:63], a[96:99], v[128:131], v[48:63]
    ds_read_b128 a[104:107], v12 offset:49152
    ds_read_b64_tr_b16 v[136:137], v154 offset:49152
    s_add_u32 m0, s51, 71680
    ds_read_b64_tr_b16 v[138:139], v154 offset:49664
    buffer_load_dwordx4 v8, s[8:11], s76 offen offset:2048 lds
    v_mfma_f32_16x16x32_bf16 v[36:39], v[16:19], v[128:131], v[36:39]
    v_mfma_f32_16x16x32_bf16 v[252:255], v[16:19], a[96:99], v[252:255]
    v_mfma_f32_4x4x4_16b_bf16 v[248:251], a[96:97], a[96:97], v[248:251]
    v_mfma_f32_4x4x4_16b_bf16 v[32:35], a[98:99], a[98:99], v[32:35]
    s_waitcnt lgkmcnt(3)
    v_mfma_f32_32x32x16_bf16 v[48:63], a[100:103], v[132:135], v[48:63]
    ds_read_b128 a[108:111], v13 offset:49152
    ds_read_b64_tr_b16 v[140:141], v155 offset:49152
    ds_read_b64_tr_b16 v[142:143], v155 offset:49664
    buffer_load_dwordx4 v9, s[8:11], s76 offen offset:3072 lds
    v_mfma_f32_16x16x32_bf16 v[252:255], v[16:19], a[100:103], v[252:255]
    v_mfma_f32_4x4x4_16b_bf16 v[248:251], a[100:101], a[100:101], v[248:251]
    v_mfma_f32_4x4x4_16b_bf16 v[32:35], a[102:103], a[102:103], v[32:35]
    s_waitcnt lgkmcnt(3)
    v_mfma_f32_32x32x16_bf16 v[48:63], a[104:107], v[136:139], v[48:63]
    s_waitcnt vmcnt(4)
    s_barrier
    ds_read_b128 a[112:115], v10 offset:57344
    ds_read_b64_tr_b16 v[144:145], v152 offset:57344
    s_add_u32 m0, s51, 79872
    ds_read_b64_tr_b16 v[146:147], v152 offset:57856
    buffer_load_dwordx4 v8, s[8:11], s77 offen offset:2048 lds
    v_mfma_f32_16x16x32_bf16 v[36:39], v[16:19], v[136:139], v[36:39]
    s_waitcnt lgkmcnt(3)
    v_mfma_f32_32x32x16_bf16 v[48:63], a[108:111], v[140:143], v[48:63]
    ds_read_b128 a[116:119], v11 offset:57344
    ds_read_b64_tr_b16 v[148:149], v153 offset:57344
    ds_read_b64_tr_b16 v[150:151], v153 offset:57856
    buffer_load_dwordx4 v9, s[8:11], s77 offen offset:3072 lds
    s_waitcnt lgkmcnt(3)
    v_mfma_f32_32x32x16_bf16 v[48:63], a[112:115], v[144:147], v[48:63]
    ds_read_b128 a[120:123], v12 offset:57344
    ds_read_b64_tr_b16 v[128:129], v154 offset:57344
    ds_read_b64_tr_b16 v[130:131], v154 offset:57856
    ds_read_b128 v[24:27], v14
    s_add_u32 m0, s51, 88064
    ds_read_b128 v[28:31], v15
    buffer_load_dwordx4 v8, s[8:11], s78 offen offset:2048 lds
    v_mfma_f32_16x16x32_bf16 v[36:39], v[16:19], v[144:147], v[36:39]
    v_mfma_f32_16x16x32_bf16 v[252:255], v[16:19], a[112:115], v[252:255]
    v_mfma_f32_4x4x4_16b_bf16 v[248:251], a[112:113], a[112:113], v[248:251]
    v_mfma_f32_4x4x4_16b_bf16 v[32:35], a[114:115], a[114:115], v[32:35]
    s_waitcnt lgkmcnt(5)
    v_mfma_f32_32x32x16_bf16 v[48:63], a[116:119], v[148:151], v[48:63]
    ds_read_b128 a[124:127], v13 offset:57344
    ds_read_b64_tr_b16 v[132:133], v155 offset:57344
    ds_read_b64_tr_b16 v[134:135], v155 offset:57856
    buffer_load_dwordx4 v9, s[8:11], s78 offen offset:3072 lds
    v_subrev_u32 v152, 0x10000, v156
    v_mfma_f32_16x16x32_bf16 v[252:255], v[16:19], a[116:119], v[252:255]
    v_subrev_u32 v153, 0x10000, v157
    v_mfma_f32_4x4x4_16b_bf16 v[248:251], a[116:117], a[116:117], v[248:251]
    v_subrev_u32 v154, 0x10000, v158
    v_mfma_f32_4x4x4_16b_bf16 v[32:35], a[118:119], a[118:119], v[32:35]
    s_waitcnt lgkmcnt(5)
    v_mfma_f32_32x32x16_bf16 v[48:63], a[120:123], v[128:131], v[48:63]
    s_waitcnt vmcnt(4)
    s_barrier
    ds_read_b64_tr_b16 v[136:137], v156 offset:0
    s_add_u32 m0, s51, 96256
    ds_read_b64_tr_b16 v[138:139], v156 offset:512
    buffer_load_dwordx4 v8, s[8:11], s79 offen offset:2048 lds
    v_mfma_f32_16x16x32_bf16 v[36:39], v[16:19], v[128:131], v[36:39]
    v_add_f32 v248, v248, v32
    v_add_f32 v249, v249, v33
    v_add_f32 v250, v250, v34
    v_add_f32 v251, v251, v35
    v_cndmask_b32 v197, v248, v249, s[96:97]
    v_cndmask_b32 v197, v197, v250, s[98:99]
    v_cndmask_b32 v197, v197, v251, s[70:71]
    v_mov_b32 v196, v197
    s_waitcnt lgkmcnt(2)
    v_mfma_f32_32x32x16_bf16 v[48:63], a[124:127], v[132:135], v[48:63]
    ds_read_b64_tr_b16 v[140:141], v157 offset:0
    ds_read_b64_tr_b16 v[142:143], v157 offset:512
    buffer_load_dwordx4 v9, s[8:11], s79 offen offset:3072 lds
    v_permlane32_swap_b32 v196, v197
    v_add_f32 v253, v196, v197
    ds_write_b64 v216, v[252:253]
    v_cvt_pk_bf16_f32 v41, v36, v36
    v_lshlrev_b32 v41, 16, v41
    v_sub_f32 v41, v36, v41
    v_cvt_pk_bf16_f32 v41, v36, v41
    ds_write_b32 v212, v41 offset:0
    s_waitcnt lgkmcnt(4)
    v_mfma_f32_32x32x16_bf16 v[64:79], a[0:3], v[136:139], 0
    ds_read_b64_tr_b16 v[144:145], v158 offset:0
    ds_read_b64_tr_b16 v[146:147], v158 offset:512
    ds_read_b64_tr_b16 v[148:149], v159 offset:0
    s_add_u32 m0, s51, 104448
    ds_read_b64_tr_b16 v[150:151], v159 offset:512
    buffer_load_dwordx4 v8, s[8:11], s80 offen offset:2048 lds
    buffer_load_dwordx4 v9, s[8:11], s80 offen offset:3072 lds
    v_subrev_u32 v155, 0x10000, v159
    s_waitcnt lgkmcnt(6)
    v_mfma_f32_32x32x16_bf16 v[64:79], a[4:7], v[140:143], v[64:79]
    ds_read_b64_tr_b16 v[128:129], v156 offset:8192
    ds_read_b64_tr_b16 v[130:131], v156 offset:8704
    ds_read_b64_tr_b16 v[132:133], v157 offset:8192
    ds_read_b64_tr_b16 v[134:135], v157 offset:8704
    s_add_u32 m0, s51, 112640
    v_mfma_f32_16x16x32_bf16 v[36:39], v[16:19], v[136:139], 0
    buffer_load_dwordx4 v8, s[8:11], s81 offen offset:2048 lds
    s_waitcnt lgkmcnt(4)
    v_mfma_f32_32x32x16_bf16 v[64:79], a[8:11], v[144:147], v[64:79]
    s_barrier
    ds_read_b64 v[198:199], v220
    ds_read_b64 v[164:165], v213 offset:0
    ds_read_b64_tr_b16 v[136:137], v158 offset:8192
    ds_read_b64_tr_b16 v[138:139], v158 offset:8704
    v_mfma_f32_16x16x32_bf16 v[36:39], v[16:19], v[144:147], v[36:39]
    buffer_load_dwordx4 v9, s[8:11], s81 offen offset:3072 lds
    s_add_u32 m0, s51, 120832
    s_nop 0
    buffer_load_dwordx4 v8, s[8:11], s82 offen offset:2048 lds
    v_mfma_f32_32x32x16_bf16 v[64:79], a[12:15], v[148:151], v[64:79]
    ds_read_b64_tr_b16 v[140:141], v159 offset:8192
    ds_read_b64_tr_b16 v[142:143], v159 offset:8704
    buffer_load_dwordx4 v9, s[8:11], s82 offen offset:3072 lds
    s_waitcnt lgkmcnt(6)
    v_mfma_f32_32x32x16_bf16 v[64:79], a[16:19], v[128:131], v[64:79]
    s_waitcnt vmcnt(8)
    s_barrier
    ds_read_b64_tr_b16 v[144:145], v156 offset:16384
    ds_read_b64_tr_b16 v[146:147], v156 offset:16896
    s_add_u32 m0, s51, 0
    v_mfma_f32_16x16x32_bf16 v[36:39], v[16:19], v[128:131], v[36:39]
    buffer_load_dwordx4 v8, s[8:11], s75 offen offset:0 lds
    s_waitcnt lgkmcnt(7)
    v_add_f32 v198, v198, v252
    v_add_f32 v197, v199, v253
    v_mul_f32 v199, 0x3b000000, v198
    v_mul_f32 v197, 0x3b000000, v197
    v_cvt_pk_bf16_f32 v198, -v199, -v199
    v_mfma_f32_32x32x16_bf16 v[64:79], a[20:23], v[132:135], v[64:79]
    ds_read_b64_tr_b16 v[148:149], v157 offset:16384
    ds_read_b64_tr_b16 v[150:151], v157 offset:16896
    buffer_load_dwordx4 v9, s[8:11], s75 offen offset:1024 lds
    v_fma_f32 v197, -v199, v199, v197
    v_cndmask_b32 v160, v198, 0, s[62:63]
    v_cndmask_b32 v161, v198, 0, s[62:63]
    v_max_f32 v197, 0, v197
    s_waitcnt lgkmcnt(6)
    v_mfma_f32_32x32x16_bf16 v[64:79], a[24:27], v[136:139], v[64:79]
    ds_read_b64_tr_b16 v[128:129], v158 offset:16384
    ds_read_b64_tr_b16 v[130:131], v158 offset:16896
    v_add_f32 v197, 0x3727c5ac, v197
    v_rsq_f32 v40, v197
    v_mfma_f32_16x16x32_bf16 v[36:39], v[16:19], v[136:139], v[36:39]
    v_cvt_pk_bf16_f32 v198, v40, v40
    v_mfma_f32_32x32x16_bf16 v[48:63], v[160:163], v[164:167], v[48:63]
    v_lshlrev_b32 v198, 16, v198
    v_sub_f32 v198, v40, v198
    v_cvt_pk_bf16_f32 v176, v40, v198
    v_cndmask_b32 v176, v176, 0, s[62:63]
    s_waitcnt lgkmcnt(4)
    v_mfma_f32_32x32x16_bf16 v[64:79], a[28:31], v[140:143], v[64:79]
    ds_read_b64_tr_b16 v[132:133], v159 offset:16384
    s_add_u32 m0, s51, 8192
    ds_read_b64_tr_b16 v[134:135], v159 offset:16896
    buffer_load_dwordx4 v8, s[8:11], s76 offen offset:0 lds
    v_mfma_f32_32x32x16_bf16 v[96:111], v[176:179], v[20:23], 0
    v_mfma_f32_32x32x16_bf16 v[64:79], a[32:35], v[144:147], v[64:79]
    ds_read_b64_tr_b16 v[136:137], v156 offset:24576
    ds_read_b64_tr_b16 v[138:139], v156 offset:25088
    buffer_load_dwordx4 v9, s[8:11], s76 offen offset:1024 lds
    v_mfma_f32_16x16x32_bf16 v[36:39], v[16:19], v[144:147], v[36:39]
    s_waitcnt lgkmcnt(4)
    v_mfma_f32_32x32x16_bf16 v[64:79], a[36:39], v[148:151], v[64:79]
    ds_read_b64_tr_b16 v[140:141], v157 offset:24576
    ds_read_b64_tr_b16 v[142:143], v157 offset:25088
    v_mfma_f32_32x32x16_bf16 v[64:79], a[40:43], v[128:131], v[64:79]
    ds_read_b64_tr_b16 v[144:145], v158 offset:24576
    ds_read_b64_tr_b16 v[146:147], v158 offset:25088
    s_add_u32 m0, s51, 16384
    v_fma_f32 v48, v48, v96, s61
    v_mfma_f32_16x16x32_bf16 v[36:39], v[16:19], v[128:131], v[36:39]
    buffer_load_dwordx4 v8, s[8:11], s77 offen offset:0 lds
    v_fma_f32 v49, v49, v97, s61
    v_fma_f32 v50, v50, v98, s61
    v_fma_f32 v51, v51, v99, s61
    s_waitcnt lgkmcnt(4)
    v_mfma_f32_32x32x16_bf16 v[64:79], a[44:47], v[132:135], v[64:79]
    ds_read_b64_tr_b16 v[148:149], v159 offset:24576
    ds_read_b64_tr_b16 v[150:151], v159 offset:25088
    v_fma_f32 v52, v52, v100, s61
    v_fma_f32 v53, v53, v101, s61
    v_fma_f32 v54, v54, v102, s61
    v_fma_f32 v55, v55, v103, s61
    v_mfma_f32_32x32x16_bf16 v[64:79], a[48:51], v[136:139], v[64:79]
    s_waitcnt vmcnt(9)
    s_barrier
    ds_read_b64_tr_b16 v[128:129], v156 offset:32768
    ds_read_b64_tr_b16 v[130:131], v156 offset:33280
    buffer_load_dwordx4 v9, s[8:11], s77 offen offset:1024 lds
    v_mfma_f32_16x16x32_bf16 v[36:39], v[16:19], v[136:139], v[36:39]
    buffer_load_dword v5, v245, s[36:39], 0 offen sc1
    v_mul_f32 v196, s55, v48
    v_mul_f32 v197, s55, v49
    v_mul_f32 v198, s55, v50
    v_mul_f32 v199, s55, v51
    s_waitcnt lgkmcnt(4)
    v_mfma_f32_32x32x16_bf16 v[64:79], a[52:55], v[140:143], v[64:79]
    ds_read_b64_tr_b16 v[132:133], v157 offset:32768
    s_add_u32 m0, s51, 24576
    ds_read_b64_tr_b16 v[134:135], v157 offset:33280
    buffer_load_dwordx4 v8, s[8:11], s78 offen offset:0 lds
    v_mul_f32 v200, s55, v52
    v_mul_f32 v201, s55, v53
    v_mul_f32 v202, s55, v54
    v_mul_f32 v203, s55, v55
    v_mfma_f32_32x32x16_bf16 v[64:79], a[56:59], v[144:147], v[64:79]
    ds_read_b64_tr_b16 v[136:137], v158 offset:32768
    ds_read_b64_tr_b16 v[138:139], v158 offset:33280
    v_exp_f32_e64 v196, v196 clamp
    v_max_f32 v48, s61, v48
    v_mfma_f32_16x16x32_bf16 v[36:39], v[16:19], v[144:147], v[36:39]
    v_exp_f32_e64 v197, v197 clamp
    v_max_f32 v49, s61, v49
    s_waitcnt lgkmcnt(4)
    v_mfma_f32_32x32x16_bf16 v[64:79], a[60:63], v[148:151], v[64:79]
    ds_read_b64_tr_b16 v[140:141], v159 offset:32768
    ds_read_b64_tr_b16 v[142:143], v159 offset:33280
    buffer_load_dwordx4 v9, s[8:11], s78 offen offset:1024 lds
    v_exp_f32_e64 v198, v198 clamp
    v_max_f32 v50, s61, v50
    v_exp_f32_e64 v199, v199 clamp
    v_max_f32 v51, s61, v51
    v_mfma_f32_32x32x16_bf16 v[64:79], a[64:67], v[128:131], v[64:79]
    ds_read_b64_tr_b16 v[144:145], v156 offset:40960
    ds_read_b64_tr_b16 v[146:147], v156 offset:41472
    v_exp_f32_e64 v200, v200 clamp
    v_max_f32 v52, s61, v52
    v_mfma_f32_16x16x32_bf16 v[36:39], v[16:19], v[128:131], v[36:39]
    v_exp_f32_e64 v201, v201 clamp
    v_max_f32 v53, s61, v53
    s_waitcnt lgkmcnt(4)
    v_mfma_f32_32x32x16_bf16 v[64:79], a[68:71], v[132:135], v[64:79]
    ds_read_b64_tr_b16 v[148:149], v157 offset:40960
    s_add_u32 m0, s51, 32768
    ds_read_b64_tr_b16 v[150:151], v157 offset:41472
    buffer_load_dwordx4 v8, s[8:11], s79 offen offset:0 lds
    v_exp_f32_e64 v202, v202 clamp
    v_max_f32 v54, s61, v54
    v_exp_f32_e64 v203, v203 clamp
    v_max_f32 v55, s61, v55
    v_mfma_f32_32x32x16_bf16 v[64:79], a[72:75], v[136:139], v[64:79]
    ds_read_b64_tr_b16 v[128:129], v158 offset:40960
    ds_read_b64_tr_b16 v[130:131], v158 offset:41472
    buffer_load_dwordx4 v9, s[8:11], s79 offen offset:1024 lds
    v_add_f32 v48, v48, v196
    v_add_f32 v49, v49, v197
    v_mfma_f32_16x16x32_bf16 v[36:39], v[16:19], v[136:139], v[36:39]
    v_add_f32 v50, v50, v198
    v_add_f32 v51, v51, v199
    s_waitcnt lgkmcnt(4)
    v_mfma_f32_32x32x16_bf16 v[64:79], a[76:79], v[140:143], v[64:79]
    ds_read_b64_tr_b16 v[132:133], v159 offset:40960
    ds_read_b64_tr_b16 v[134:135], v159 offset:41472
    v_add_f32 v52, v52, v200
    v_add_f32 v53, v53, v201
    v_add_f32 v54, v54, v202
    v_add_f32 v55, v55, v203
    v_mfma_f32_32x32x16_bf16 v[64:79], a[80:83], v[144:147], v[64:79]
    s_waitcnt vmcnt(11)
    s_barrier
    ds_read_b64_tr_b16 v[136:137], v156 offset:49152
    ds_read_b64_tr_b16 v[138:139], v156 offset:49664
    ds_read_b64_tr_b16 v[204:205], v158 offset:49152
    ds_read_b64_tr_b16 v[206:207], v158 offset:49664
    s_add_u32 m0, s51, 40960
    v_mfma_f32_16x16x32_bf16 v[36:39], v[16:19], v[144:147], v[36:39]
    buffer_load_dwordx4 v8, s[8:11], s80 offen offset:0 lds
    v_cvt_pk_bf16_f32 v180, v48, v49
    v_cvt_pk_bf16_f32 v181, v50, v51
    v_cvt_pk_bf16_f32 v182, v52, v53
    v_cvt_pk_bf16_f32 v183, v54, v55
    s_waitcnt lgkmcnt(6)
    v_mfma_f32_32x32x16_bf16 v[64:79], a[84:87], v[148:151], v[64:79]
    ds_read_b64_tr_b16 v[140:141], v157 offset:49152
    ds_read_b64_tr_b16 v[142:143], v157 offset:49664
    ds_read_b64_tr_b16 v[208:209], v156 offset:57344
    ds_read_b64_tr_b16 v[210:211], v156 offset:57856
    buffer_load_dwordx4 v9, s[8:11], s80 offen offset:1024 lds
    v_fma_f32 v56, v56, v104, s61
    v_fma_f32 v57, v57, v105, s61
    v_fma_f32 v58, v58, v106, s61
    v_fma_f32 v59, v59, v107, s61
    v_mfma_f32_32x32x16_bf16 v[64:79], a[88:91], v[128:131], v[64:79]
    ds_read_b64_tr_b16 v[144:145], v158 offset:49152
    ds_read_b64_tr_b16 v[146:147], v158 offset:49664
    ds_read_b64_tr_b16 v[44:45], v158 offset:57344
    ds_read_b64_tr_b16 v[46:47], v158 offset:57856
    v_mul_f32 v196, s55, v56
    v_mfma_f32_16x16x32_bf16 v[36:39], v[16:19], v[128:131], v[36:39]
    v_fma_f32 v60, v60, v108, s61
    v_fma_f32 v61, v61, v109, s61
    v_fma_f32 v62, v62, v110, s61
    v_fma_f32 v63, v63, v111, s61
    s_waitcnt lgkmcnt(12)
    v_mfma_f32_32x32x16_bf16 v[64:79], a[92:95], v[132:135], v[64:79]
    ds_read_b64_tr_b16 v[148:149], v159 offset:49152
    ds_read_b64_tr_b16 v[150:151], v159 offset:49664
    s_add_u32 m0, s51, 49152
    v_mul_f32 v197, s55, v57
    v_mul_f32 v198, s55, v58
    s_waitcnt lgkmcnt(10)
    v_mfma_f32_16x16x32_bf16 v[36:39], v[16:19], v[204:207], v[36:39]
    buffer_load_dwordx4 v8, s[8:11], s81 offen offset:0 lds
    v_mul_f32 v199, s55, v59
    v_mfma_f32_32x32x16_bf16 v[64:79], a[96:99], v[136:139], v[64:79]
    ds_read_b64_tr_b16 v[128:129], v156 offset:57344
    ds_read_b64_tr_b16 v[130:131], v156 offset:57856
    v_mul_f32 v200, s55, v60
    v_mul_f32 v201, s55, v61
    v_mul_f32 v202, s55, v62
    v_mfma_f32_16x16x32_bf16 v[36:39], v[16:19], v[136:139], v[36:39]
    v_mul_f32 v203, s55, v63
    s_waitcnt lgkmcnt(8)
    v_mfma_f32_16x16x32_bf16 v[36:39], v[16:19], v[208:211], v[36:39]
    v_max_f32 v56, s61, v56
    v_mfma_f32_32x32x16_bf16 v[64:79], a[100:103], v[140:143], v[64:79]
    ds_read_b64_tr_b16 v[132:133], v157 offset:57344
    ds_read_b64_tr_b16 v[134:135], v157 offset:57856
    buffer_load_dwordx4 v9, s[8:11], s81 offen offset:1024 lds
    v_exp_f32_e64 v196, v196 clamp
    s_waitcnt lgkmcnt(6)
    v_mfma_f32_16x16x32_bf16 v[36:39], v[16:19], v[44:47], v[36:39]
    v_exp_f32_e64 v197, v197 clamp
    v_max_f32 v57, s61, v57
    v_mfma_f32_32x32x16_bf16 v[64:79], a[104:107], v[144:147], v[64:79]
    ds_read_b64_tr_b16 v[136:137], v158 offset:57344
    ds_read_b64_tr_b16 v[138:139], v158 offset:57856
    s_nop 2
    v_cvt_pk_bf16_f32 v41, v36, v36
    v_lshlrev_b32 v41, 16, v41
    v_sub_f32 v41, v36, v41
    v_cvt_pk_bf16_f32 v41, v36, v41
    ds_write_b32 v212, v41 offset:512
    s_add_u32 m0, s51, 57344
    s_nop 0
    buffer_load_dwordx4 v8, s[8:11], s82 offen offset:0 lds
    v_exp_f32_e64 v198, v198 clamp
    v_max_f32 v58, s61, v58
    v_exp_f32_e64 v199, v199 clamp
    v_max_f32 v59, s61, v59
    s_waitcnt lgkmcnt(5)
    v_mfma_f32_32x32x16_bf16 v[64:79], a[108:111], v[148:151], v[64:79]
    ds_read_b64_tr_b16 v[140:141], v159 offset:57344
    ds_read_b64_tr_b16 v[142:143], v159 offset:57856
    v_exp_f32_e64 v200, v200 clamp
    v_max_f32 v60, s61, v60
    v_exp_f32_e64 v201, v201 clamp
    v_max_f32 v61, s61, v61
    v_mfma_f32_32x32x16_bf16 v[64:79], a[112:115], v[128:131], v[64:79]
    s_waitcnt vmcnt(12) lgkmcnt(2)
    s_barrier
    ds_read_b64 v[168:169], v213 offset:512
    ds_read_b64_tr_b16 v[144:145], v152 offset:0
    ds_read_b64_tr_b16 v[146:147], v152 offset:512
    buffer_load_dwordx4 v9, s[8:11], s82 offen offset:1024 lds
    v_exp_f32_e64 v202, v202 clamp
    v_max_f32 v62, s61, v62
    v_exp_f32_e64 v203, v203 clamp
    v_max_f32 v63, s61, v63
    v_mfma_f32_32x32x16_bf16 v[64:79], a[116:119], v[132:135], v[64:79]
    ds_read_b64_tr_b16 v[148:149], v153 offset:0
    ds_read_b64_tr_b16 v[150:151], v153 offset:512
    v_add_f32 v56, v56, v196
    v_add_f32 v57, v57, v197
    v_add_f32 v58, v58, v198
    v_add_f32 v59, v59, v199
    v_mfma_f32_32x32x16_bf16 v[64:79], a[120:123], v[136:139], v[64:79]
    ds_read_b64_tr_b16 v[128:129], v154 offset:0
    ds_read_b64_tr_b16 v[130:131], v154 offset:512
    v_add_f32 v60, v60, v200
    v_add_f32 v61, v61, v201
    v_add_f32 v62, v62, v202
    v_add_f32 v63, v63, v203
    s_waitcnt lgkmcnt(6)
    v_mfma_f32_32x32x16_bf16 v[64:79], a[124:127], v[140:143], v[64:79]
    ds_read_b64_tr_b16 v[132:133], v155 offset:0
    ds_read_b64_tr_b16 v[134:135], v155 offset:512
    v_cvt_pk_bf16_f32 v184, v56, v57
    v_cvt_pk_bf16_f32 v185, v58, v59
    v_cvt_pk_bf16_f32 v186, v60, v61
    v_cvt_pk_bf16_f32 v187, v62, v63
    v_mfma_f32_32x32x16_bf16 v[64:79], v[160:163], v[168:171], v[64:79]
    s_waitcnt lgkmcnt(4)
    v_mfma_f32_32x32x16_bf16 v[80:95], v[144:147], a[0:3], 0
    ds_read_b64_tr_b16 v[136:137], v152 offset:8192
    ds_read_b64_tr_b16 v[138:139], v152 offset:8704
    s_add_u32 m0, s95, 4096
    v_mfma_f32_16x16x32_bf16 v[36:39], v[16:19], v[144:147], 0
    buffer_load_dwordx4 v239, s[24:27], s92 offen nt lds
    s_nop 4
    v_mul_f32 v64, v64, v96
    v_mul_f32 v65, v65, v97
    v_mul_f32 v66, v66, v98
    v_mul_f32 v67, v67, v99
    v_mfma_f32_32x32x16_bf16 v[80:95], v[148:151], a[4:7], v[80:95]
    ds_read_b64_tr_b16 v[140:141], v153 offset:8192
    ds_read_b64_tr_b16 v[142:143], v153 offset:8704
    buffer_load_dwordx4 v239, s[24:27], s94 offen offset:1024 nt lds
    v_mul_f32 v68, v68, v100
    v_mul_f32 v69, v69, v101
    v_mul_f32 v70, v70, v102
    v_mul_f32 v71, v71, v103
    s_waitcnt lgkmcnt(4)
    v_mfma_f32_32x32x16_bf16 v[80:95], v[128:131], a[8:11], v[80:95]
    ds_read_b64_tr_b16 v[144:145], v154 offset:8192
    ds_read_b64_tr_b16 v[146:147], v154 offset:8704
    buffer_load_dword v42, v42, s[12:15], s68 offen
    v_mul_f32 v72, v72, v104
    v_mul_f32 v73, v73, v105
    v_mfma_f32_16x16x32_bf16 v[36:39], v[16:19], v[128:131], v[36:39]
    v_mul_f32 v74, v74, v106
    v_mul_f32 v75, v75, v107
    v_mfma_f32_32x32x16_bf16 v[80:95], v[132:135], a[12:15], v[80:95]
    ds_read_b64_tr_b16 v[148:149], v155 offset:8192
    s_add_u32 m0, s95, 0
    ds_read_b64_tr_b16 v[150:151], v155 offset:8704
    buffer_load_dwordx4 v237, s[16:19], s90 offen nt lds
    v_mul_f32 v76, v76, v108
    v_mul_f32 v77, v77, v109
    v_mul_f32 v78, v78, v110
    v_mul_f32 v79, v79, v111
    s_waitcnt lgkmcnt(4)
    v_mfma_f32_32x32x16_bf16 v[80:95], v[136:139], a[16:19], v[80:95]
    s_waitcnt vmcnt(12)
    s_barrier
    ds_read_b64_tr_b16 v[128:129], v152 offset:16384
    ds_read_b64_tr_b16 v[130:131], v152 offset:16896
    buffer_load_dwordx4 v237, s[16:19], s91 offen offset:1024 nt lds
    v_mfma_f32_16x16x32_bf16 v[36:39], v[16:19], v[136:139], v[36:39]
    v_cvt_pk_bf16_f32 v188, v64, v65
    v_cvt_pk_bf16_f32 v189, v66, v67
    v_cvt_pk_bf16_f32 v190, v68, v69
    v_cvt_pk_bf16_f32 v191, v70, v71
    v_mfma_f32_32x32x16_bf16 v[80:95], v[140:143], a[20:23], v[80:95]
    ds_read_b64_tr_b16 v[132:133], v153 offset:16384
    s_add_u32 m0, s95, 2048
    ds_read_b64_tr_b16 v[134:135], v153 offset:16896
    buffer_load_dwordx4 v238, s[20:23], s90 offen nt lds
    v_cvt_pk_bf16_f32 v192, v72, v73
    v_cvt_pk_bf16_f32 v193, v74, v75
    v_cvt_pk_bf16_f32 v194, v76, v77
    v_cvt_pk_bf16_f32 v195, v78, v79
    s_waitcnt lgkmcnt(6)
    v_mfma_f32_32x32x16_bf16 v[80:95], v[144:147], a[24:27], v[80:95]
    ds_read_b64_tr_b16 v[136:137], v154 offset:16384
    ds_read_b64_tr_b16 v[138:139], v154 offset:16896
    buffer_load_dwordx4 v238, s[20:23], s91 offen offset:1024 nt lds
    v_mfma_f32_16x16x32_bf16 v[36:39], v[16:19], v[144:147], v[36:39]
    v_mfma_f32_32x32x16_bf16 v[112:127], v[180:183], v[188:191], 0
    v_mfma_f32_32x32x16_bf16 v[112:127], v[184:187], v[192:195], v[112:127]
    v_mfma_f32_16x16x32_bf16 v[44:47], v[16:19], v[180:183], 0
    v_mfma_f32_16x16x32_bf16 v[44:47], v[16:19], v[184:187], v[44:47]
    s_waitcnt lgkmcnt(6)
    v_mfma_f32_32x32x16_bf16 v[80:95], v[148:151], a[28:31], v[80:95]
    ds_read_b64_tr_b16 v[140:141], v155 offset:16384
    ds_read_b64_tr_b16 v[142:143], v155 offset:16896
    v_and_b32 v43, 63, v5
    v_cmp_gt_u32 vcc, 32, v43
    s_nop 0
    s_and_b64 vcc, vcc, 1
    s_cbranch_scc1 L_o_6
L_r_7:
    s_waitcnt lgkmcnt(4)
    v_mfma_f32_32x32x16_bf16 v[80:95], v[128:131], a[32:35], v[80:95]
    ds_read_b64_tr_b16 v[144:145], v152 offset:24576
    ds_read_b64_tr_b16 v[146:147], v152 offset:25088
    v_cndmask_b32 v196, v112, v120, s[64:65]
    v_cndmask_b32 v197, v113, v121, s[64:65]
    v_mfma_f32_16x16x32_bf16 v[36:39], v[16:19], v[128:131], v[36:39]
    v_cndmask_b32 v198, v114, v122, s[64:65]
    v_cndmask_b32 v199, v115, v123, s[64:65]
    v_cndmask_b32 v200, v116, v124, s[64:65]
    v_cndmask_b32 v201, v117, v125, s[64:65]
    v_mfma_f32_32x32x16_bf16 v[80:95], v[132:135], a[36:39], v[80:95]
    ds_read_b64_tr_b16 v[148:149], v153 offset:24576
    ds_read_b64_tr_b16 v[150:151], v153 offset:25088
    ds_write_b128 v214, v[196:199]
    v_cndmask_b32 v202, v118, v126, s[64:65]
    v_cndmask_b32 v203, v119, v127, s[64:65]
    ds_write_b128 v214, v[200:203] offset:512
    ds_write_b32 v215, v44
    s_waitcnt lgkmcnt(7)
    v_mfma_f32_32x32x16_bf16 v[80:95], v[136:139], a[40:43], v[80:95]
    ds_read_b64_tr_b16 v[128:129], v154 offset:24576
    ds_read_b64_tr_b16 v[130:131], v154 offset:25088
    v_mfma_f32_16x16x32_bf16 v[36:39], v[16:19], v[136:139], v[36:39]
    v_mfma_f32_32x32x16_bf16 v[80:95], v[140:143], a[44:47], v[80:95]
    s_waitcnt vmcnt(7) lgkmcnt(2)
    s_barrier
    ds_read_b64_tr_b16 v[132:133], v155 offset:24576
    ds_read_b64_tr_b16 v[134:135], v155 offset:25088
    ds_read2st64_b32 v[112:113], v217 offset0:0 offset1:8
    ds_read2st64_b32 v[114:115], v217 offset0:1 offset1:9
    ds_read2st64_b32 v[116:117], v217 offset0:2 offset1:10
    v_mfma_f32_32x32x16_bf16 v[80:95], v[144:147], a[48:51], v[80:95]
    ds_read_b64_tr_b16 v[136:137], v152 offset:32768
    ds_read_b64_tr_b16 v[138:139], v152 offset:33280
    ds_read2st64_b32 v[118:119], v217 offset0:3 offset1:11
    ds_read2_b32 v[120:121], v218 offset0:0 offset1:32
    v_mfma_f32_16x16x32_bf16 v[36:39], v[16:19], v[144:147], v[36:39]
    v_mfma_f32_32x32x16_bf16 v[80:95], v[148:151], a[52:55], v[80:95]
    ds_read_b64_tr_b16 v[140:141], v153 offset:32768
    ds_read_b64_tr_b16 v[142:143], v153 offset:33280
    s_lshl_b32 s67, s40, 12
    s_waitcnt lgkmcnt(9)
    v_mfma_f32_32x32x16_bf16 v[80:95], v[128:131], a[56:59], v[80:95]
    ds_read_b64_tr_b16 v[144:145], v154 offset:32768
    ds_read_b64_tr_b16 v[146:147], v154 offset:33280
    v_mfma_f32_16x16x32_bf16 v[36:39], v[16:19], v[128:131], v[36:39]
    s_waitcnt lgkmcnt(10)
    v_add_f32 v112, v112, v113
    s_waitcnt lgkmcnt(9)
    v_add_f32 v114, v114, v115
    v_mfma_f32_32x32x16_bf16 v[80:95], v[132:135], a[60:63], v[80:95]
    ds_read_b64_tr_b16 v[148:149], v155 offset:32768
    ds_read_b64_tr_b16 v[150:151], v155 offset:33280
    s_waitcnt lgkmcnt(10)
    v_add_f32 v116, v116, v117
    s_waitcnt lgkmcnt(7)
    v_add_f32 v118, v118, v119
    v_mfma_f32_32x32x16_bf16 v[80:95], v[136:139], a[64:67], v[80:95]
    ds_read_b64_tr_b16 v[128:129], v152 offset:40960
    ds_read_b64_tr_b16 v[130:131], v152 offset:41472
    buffer_atomic_add_f32 v112, v3, s[32:35], s84 offen offset:0
    v_mfma_f32_16x16x32_bf16 v[36:39], v[16:19], v[136:139], v[36:39]
    s_waitcnt lgkmcnt(8)
    v_add_f32 v120, v120, v121
    s_waitcnt lgkmcnt(4)
    v_mfma_f32_32x32x16_bf16 v[80:95], v[140:143], a[68:71], v[80:95]
    ds_read_b64_tr_b16 v[132:133], v153 offset:40960
    ds_read_b64_tr_b16 v[134:135], v153 offset:41472
    buffer_atomic_add_f32 v114, v3, s[32:35], s84 offen offset:256
    buffer_atomic_add_f32 v116, v3, s[32:35], s84 offen offset:512
    v_mfma_f32_32x32x16_bf16 v[80:95], v[144:147], a[72:75], v[80:95]
    ds_read_b64_tr_b16 v[136:137], v154 offset:40960
    ds_read_b64_tr_b16 v[138:139], v154 offset:41472
    buffer_atomic_add_f32 v118, v3, s[32:35], s84 offen offset:768
    buffer_atomic_add_f32 v120, v219, s[32:35], s85 offen
    v_mfma_f32_16x16x32_bf16 v[36:39], v[16:19], v[144:147], v[36:39]
    s_waitcnt lgkmcnt(4)
    v_mfma_f32_32x32x16_bf16 v[80:95], v[148:151], a[76:79], v[80:95]
    ds_read_b64_tr_b16 v[140:141], v155 offset:40960
    ds_read_b64_tr_b16 v[142:143], v155 offset:41472
    v_readfirstlane_b32 s46, v5
    s_nop 0
    s_bfe_u32 s47, s46, 0x60006
    s_bfe_u32 s58, s46, 0x6000c
    v_mfma_f32_32x32x16_bf16 v[80:95], v[128:131], a[80:83], v[80:95]
    ds_read_b64_tr_b16 v[144:145], v152 offset:49152
    ds_read_b64_tr_b16 v[146:147], v152 offset:49664
    ds_read_b64_tr_b16 v[204:205], v154 offset:49152
    ds_read_b64_tr_b16 v[206:207], v154 offset:49664
    s_lshr_b32 s46, s46, 5
    v_mfma_f32_16x16x32_bf16 v[36:39], v[16:19], v[128:131], v[36:39]
    s_cmp_gt_u32 s58, s47
    s_cselect_b32 s47, -1, 0
    s_waitcnt lgkmcnt(6)
    v_mfma_f32_32x32x16_bf16 v[80:95], v[132:135], a[84:87], v[80:95]
    ds_read_b64_tr_b16 v[148:149], v153 offset:49152
    ds_read_b64_tr_b16 v[150:151], v153 offset:49664
    ds_read_b64_tr_b16 v[208:209], v152 offset:57344
    ds_read_b64_tr_b16 v[210:211], v152 offset:57856
    s_xor_b32 s99, s46, s47
    s_and_b32 s46, s57, 6
    v_mfma_f32_32x32x16_bf16 v[80:95], v[136:139], a[88:91], v[80:95]
    ds_read_b64_tr_b16 v[128:129], v154 offset:49152
    ds_read_b64_tr_b16 v[130:131], v154 offset:49664
    ds_read_b64_tr_b16 v[44:45], v154 offset:57344
    ds_read_b64_tr_b16 v[46:47], v154 offset:57856
    s_lshr_b32 s46, s99, s46
    v_mfma_f32_16x16x32_bf16 v[36:39], v[16:19], v[136:139], v[36:39]
    s_lshl_b32 s47, s41, 10
    s_waitcnt lgkmcnt(12)
    v_mfma_f32_32x32x16_bf16 v[80:95], v[140:143], a[92:95], v[80:95]
    ds_read_b64_tr_b16 v[132:133], v155 offset:49152
    ds_read_b64_tr_b16 v[134:135], v155 offset:49664
    s_xor_b32 s96, s46, s47
    s_and_b32 s96, s96, 0x2000
    v_mov_b32 v176, 0
    s_waitcnt lgkmcnt(10)
    v_mfma_f32_16x16x32_bf16 v[36:39], v[16:19], v[204:207], v[36:39]
    v_lshrrev_b32_e64 v244, v1, s99
    v_mfma_f32_32x32x16_bf16 v[80:95], v[144:147], a[96:99], v[80:95]
    ds_read_b64_tr_b16 v[136:137], v152 offset:57344
    ds_read_b64_tr_b16 v[138:139], v152 offset:57856
    v_and_b32 v244, 0x2000, v244
    v_lshl_add_u32 v244, v1, 14, v244
    v_mfma_f32_16x16x32_bf16 v[36:39], v[16:19], v[144:147], v[36:39]
    v_or_b32 v244, v244, v246
    s_waitcnt lgkmcnt(8)
    v_mfma_f32_16x16x32_bf16 v[36:39], v[16:19], v[208:211], v[36:39]
    s_xor_b32 s86, s86, s96
    s_lshr_b32 s97, s99, 3
    v_mfma_f32_32x32x16_bf16 v[80:95], v[148:151], a[100:103], v[80:95]
    ds_read_b64_tr_b16 v[140:141], v153 offset:57344
    ds_read_b64_tr_b16 v[142:143], v153 offset:57856
    s_and_b32 s97, s97, 0x2000
    s_lshl_b32 s58, s41, 12
    v_mov_b32 v204, s55
    s_waitcnt lgkmcnt(4)
    v_mfma_f32_16x16x32_bf16 v[36:39], v[16:19], v[44:47], v[36:39]
    v_mfma_f32_32x32x16_bf16 v[80:95], v[128:131], a[104:107], v[80:95]
    ds_read_b64_tr_b16 v[144:145], v154 offset:57344
    ds_read_b64_tr_b16 v[146:147], v154 offset:57856
    s_nop 4
    v_cvt_pk_bf16_f32 v41, v36, v36
    v_lshlrev_b32 v41, 16, v41
    v_sub_f32 v41, v36, v41
    v_cvt_pk_bf16_f32 v41, v36, v41
    ds_write_b32 v212, v41 offset:1024
    s_xor_b32 s98, s47, s58
    s_and_b32 s98, s98, 0x2000
    v_mfma_f32_32x32x16_bf16 v[80:95], v[132:135], a[108:111], v[80:95]
    ds_read_b64_tr_b16 v[148:149], v155 offset:57344
    ds_read_b64_tr_b16 v[150:151], v155 offset:57856
    s_xor_b32 s98, s98, s97
    s_xor_b32 s83, s83, s98
    v_mov_b32 v41, s61
    s_waitcnt lgkmcnt(5)
    v_mfma_f32_32x32x16_bf16 v[80:95], v[136:139], a[112:115], v[80:95]
    s_waitcnt lgkmcnt(2)
    s_barrier
    ds_read_b64 v[172:173], v213 offset:1024
    v_mfma_f32_32x32x16_bf16 v[80:95], v[140:143], a[116:119], v[80:95]
    v_mfma_f32_32x32x16_bf16 v[80:95], v[144:147], a[120:123], v[80:95]
    buffer_store_dwordx4 v[176:179], v2, s[32:35], s83 offen offset:3072 sc1
    s_waitcnt lgkmcnt(1)
    v_mfma_f32_32x32x16_bf16 v[80:95], v[148:151], a[124:127], v[80:95]
    s_waitcnt lgkmcnt(0)
    v_mfma_f32_32x32x16_bf16 v[80:95], v[172:175], v[160:163], v[80:95]
    s_nop 11
    v_pk_fma_f32 v[80:81], v[80:81], v[40:41], v[40:41] op_sel:[0,0,1] op_sel_hi:[1,0,1]
    v_pk_fma_f32 v[82:83], v[82:83], v[40:41], v[40:41] op_sel:[0,0,1] op_sel_hi:[1,0,1]
    v_pk_fma_f32 v[84:85], v[84:85], v[40:41], v[40:41] op_sel:[0,0,1] op_sel_hi:[1,0,1]
    v_pk_fma_f32 v[86:87], v[86:87], v[40:41], v[40:41] op_sel:[0,0,1] op_sel_hi:[1,0,1]
    v_pk_mul_f32 v[196:197], v[80:81], v[204:205] op_sel_hi:[1,0]
    v_pk_mul_f32 v[198:199], v[82:83], v[204:205] op_sel_hi:[1,0]
    v_pk_mul_f32 v[200:201], v[84:85], v[204:205] op_sel_hi:[1,0]
    v_pk_mul_f32 v[202:203], v[86:87], v[204:205] op_sel_hi:[1,0]
    v_exp_f32_e64 v196, v196 clamp
    v_max_f32 v80, s61, v80
    v_exp_f32_e64 v197, v197 clamp
    v_max_f32 v81, s61, v81
    v_exp_f32_e64 v198, v198 clamp
    v_max_f32 v82, s61, v82
    v_exp_f32_e64 v199, v199 clamp
    v_max_f32 v83, s61, v83
    v_exp_f32_e64 v200, v200 clamp
    v_max_f32 v84, s61, v84
    v_exp_f32_e64 v201, v201 clamp
    v_max_f32 v85, s61, v85
    v_exp_f32_e64 v202, v202 clamp
    v_max_f32 v86, s61, v86
    v_exp_f32_e64 v203, v203 clamp
    v_max_f32 v87, s61, v87
    v_pk_add_f32 v[80:81], v[80:81], v[196:197]
    v_pk_add_f32 v[82:83], v[82:83], v[198:199]
    v_pk_add_f32 v[84:85], v[84:85], v[200:201]
    v_pk_add_f32 v[86:87], v[86:87], v[202:203]
    v_cvt_pk_bf16_f32 v180, v80, v81
    v_cvt_pk_bf16_f32 v181, v82, v83
    v_cvt_pk_bf16_f32 v182, v84, v85
    v_cvt_pk_bf16_f32 v183, v86, v87
    buffer_store_dwordx4 v[180:183], v2, s[32:35], s86 offen sc1
    v_pk_fma_f32 v[88:89], v[88:89], v[40:41], v[40:41] op_sel:[0,0,1] op_sel_hi:[1,0,1]
    v_pk_fma_f32 v[90:91], v[90:91], v[40:41], v[40:41] op_sel:[0,0,1] op_sel_hi:[1,0,1]
    v_pk_fma_f32 v[92:93], v[92:93], v[40:41], v[40:41] op_sel:[0,0,1] op_sel_hi:[1,0,1]
    v_pk_fma_f32 v[94:95], v[94:95], v[40:41], v[40:41] op_sel:[0,0,1] op_sel_hi:[1,0,1]
    v_pk_mul_f32 v[196:197], v[88:89], v[204:205] op_sel_hi:[1,0]
    v_pk_mul_f32 v[198:199], v[90:91], v[204:205] op_sel_hi:[1,0]
    v_pk_mul_f32 v[200:201], v[92:93], v[204:205] op_sel_hi:[1,0]
    v_pk_mul_f32 v[202:203], v[94:95], v[204:205] op_sel_hi:[1,0]
    v_exp_f32_e64 v196, v196 clamp
    v_max_f32 v88, s61, v88
    v_exp_f32_e64 v197, v197 clamp
    v_max_f32 v89, s61, v89
    v_exp_f32_e64 v198, v198 clamp
    v_max_f32 v90, s61, v90
    v_exp_f32_e64 v199, v199 clamp
    v_max_f32 v91, s61, v91
    v_exp_f32_e64 v200, v200 clamp
    v_max_f32 v92, s61, v92
    v_exp_f32_e64 v201, v201 clamp
    v_max_f32 v93, s61, v93
    v_exp_f32_e64 v202, v202 clamp
    v_max_f32 v94, s61, v94
    v_exp_f32_e64 v203, v203 clamp
    v_max_f32 v95, s61, v95
    v_pk_add_f32 v[88:89], v[88:89], v[196:197]
    v_pk_add_f32 v[90:91], v[90:91], v[198:199]
    v_pk_add_f32 v[92:93], v[92:93], v[200:201]
    v_pk_add_f32 v[94:95], v[94:95], v[202:203]
    v_cvt_pk_bf16_f32 v184, v88, v89
    v_cvt_pk_bf16_f32 v185, v90, v91
    v_cvt_pk_bf16_f32 v186, v92, v93
    v_cvt_pk_bf16_f32 v187, v94, v95
    buffer_store_dwordx4 v[184:187], v2, s[32:35], s86 offen offset:1024 sc1
    s_barrier
    s_add_u32 s44, s66, 0
    s_add_u32 m0, s67, 0
    s_and_b32 s44, s44, 0x7ffff
    buffer_load_dwordx4 v221, s[12:15], s44 offen offset:0 lds
    buffer_load_dwordx4 v222, s[12:15], s44 offen offset:1024 lds
    buffer_load_dwordx4 v223, s[12:15], s44 offen offset:2048 lds
    buffer_load_dwordx4 v224, s[12:15], s44 offen offset:3072 lds
    s_add_u32 s44, s66, 65536
    s_add_u32 m0, s67, 16384
    s_and_b32 s44, s44, 0x7ffff
    buffer_load_dwordx4 v221, s[12:15], s44 offen offset:0 lds
    buffer_load_dwordx4 v222, s[12:15], s44 offen offset:1024 lds
    s_bfe_u32 s52, s2, 0x10006
    s_and_b32 s47, s74, 62
    s_add_u32 s52, s52, s47
    s_lshl_b32 s58, s54, 1
    s_add_u32 s58, s58, s40
    s_and_b32 s58, s58, 7
    s_lshl_b32 s90, s58, 12
    s_add_u32 s90, s90, 0x10000
    s_xor_b32 s18, s90, 0x4000
    s_lshl_b32 s46, s52, 16
    s_and_b32 s92, s58, 6
    s_add_u32 s92, s92, s58
    s_lshl_b32 s92, s92, 12
    s_add_u32 s92, s92, s46
    s_add_u32 s92, s92, 0x400000
    s_xor_b32 s92, s92, s96
    s_xor_b32 s19, s92, 0x8000
    s_lshl_b32 s58, s58, 8
    s_mov_b32 s91, 0x1f800
    s_lshl_b32 s94, s53, 14
    s_add_u32 s94, s94, s46
    s_add_u32 s94, s94, s51
    s_add_u32 s94, s94, 0x800000
    s_xor_b32 s94, s94, s97
    s_lshl_b32 s95, s52, 4
    s_add_u32 s95, s95, s53
    s_lshl_b32 s95, s95, 14
    s_add_u32 s95, s95, 0x1001f00
    s_xor_b32 s95, s95, s98
    s_lshl_b32 s69, s52, 2
    s_add_u32 s69, s69, s53
    s_lshl_b32 s69, s69, 16
    s_add_u32 s69, s69, s50
    s_add_u32 s69, s69, 0x1001c00
    s_xor_b32 s69, s69, s98
    s_lshl_b32 s17, s40, 13
    s_lshr_b32 s46, s99, s57
    s_and_b32 s46, s46, 0x2000
    s_lshl_b32 s20, s57, 14
    s_add_u32 s20, s20, s46
    s_add_u32 s20, s20, 0x20000
    s_add_u32 s21, s20, 4096
    s_bfe_i32 s45, s99, 0x10010
    s_xor_b32 s45, s45, s99
    s_and_b32 s45, s45, 0xe000
    s_bcnt1_i32_b32 s45, s45
    s_sub_u32 s45, s57, s45
    s_and_b32 s24, s45, 4
    s_lshl_b32 s24, s24, 1
    s_and_b32 s46, s56, 7
    s_add_u32 s24, s24, s46
    s_and_b32 s25, s45, 3
    s_lshl_b32 s25, s25, 2
    s_lshr_b32 s46, s56, 3
    s_add_u32 s25, s25, s46
    s_lshl_b32 s45, s24, 10
    s_lshl_b32 s46, s24, 12
    s_xor_b32 s98, s45, s46
    s_and_b32 s98, s98, 0x2000
    s_xor_b32 s98, s98, s97
    s_lshl_b32 s16, s25, 19
    s_add_u32 s16, s16, s50
    s_and_b32 s46, s25, 1
    s_lshl_b32 s46, s46, 13
    s_add_u32 s16, s16, s46
    s_add_u32 s16, s16, 0x2000000
    s_xor_b32 s22, s16, 0x2000
    s_lshl_b32 s45, s24, 2
    s_add_u32 s46, s45, s40
    s_lshl_b32 s83, s46, 4
    s_add_u32 s83, s83, s25
    s_lshl_b32 s83, s83, 14
    s_add_u32 s83, s83, 0x1001000
    s_xor_b32 s83, s83, s98
    s_lshl_b32 s75, s46, 16
    s_add_u32 s75, s75, 0x800000
    s_xor_b32 s75, s75, s97
    s_sub_u32 s77, s83, 4096
    s_lshl_b32 s47, s25, 14
    s_sub_u32 s7, s83, s47
    s_add_u32 s7, s7, 3584
    s_add_u32 s76, s7, 256
    s_mul_i32 s79, s25, 896
    s_add_u32 s79, s79, 0x1c000
    s_and_b32 s53, s25, 7
    s_lshl_b32 s80, s53, 19
    s_lshl_b32 s47, s40, 17
    s_add_u32 s80, s80, s47
    s_lshl_b32 s47, s53, 11
    s_xor_b32 s47, s47, s20
    s_and_b32 s47, s47, 0x2000
    s_add_u32 s80, s80, s47
    s_add_u32 s80, s80, 0x2800000
    s_xor_b32 s23, s80, 0x2000
    s_and_b32 s47, s40, 1
    s_lshl_b32 s46, s47, 10
    v_and_b32 v41, 31, v1
    v_lshrrev_b32 v209, 5, v1
    v_lshlrev_b32 v41, 3, v41
    v_lshl_add_u32 v41, v209, 10, v41
    v_xor_b32 v41, s58, v41
    v_lshlrev_b32 v192, 16, v24
    v_and_b32 v193, s60, v24
    v_lshlrev_b32 v194, 16, v25
    v_and_b32 v195, s60, v25
    v_lshlrev_b32 v196, 16, v26
    v_and_b32 v197, s60, v26
    v_lshlrev_b32 v198, 16, v27
    v_and_b32 v199, s60, v27
    v_lshlrev_b32 v200, 16, v28
    v_and_b32 v201, s60, v28
    v_lshlrev_b32 v202, 16, v29
    v_and_b32 v203, s60, v29
    v_lshlrev_b32 v204, 16, v30
    v_and_b32 v205, s60, v30
    v_lshlrev_b32 v206, 16, v31
    v_and_b32 v207, s60, v31
    v_bfe_u32 v46, v1, 4, 1
    v_and_b32 v45, 0xf0, v2
    v_lshl_add_u32 v45, v46, 9, v45
    v_lshrrev_b32 v46, 5, v1
    v_lshlrev_b32 v43, 14, v1
    v_and_b32 v247, 12, v3
    v_or_b32 v247, v247, v246
    v_bfe_u32 v44, v1, 2, 1
    v_lshl_add_u32 v247, v44, 18, v247
    v_add_u32 v6, s46, v45
    v_xor_b32 v7, 1024, v6
    v_lshrrev_b32 v44, 4, v1
    v_lshl_add_u32 v212, v44, 8, v2
    v_and_b32 v212, 0xffff, v212
    v_add_u32 v8, 0x10000, v212
    v_add_u32 v9, 0x20000, v212
    s_add_u32 s46, s17, 0x10000
    v_add_u32 v10, s46, v6
    v_add_u32 v11, s46, v7
    v_lshl_add_u32 v10, v46, 11, v10
    v_lshl_add_u32 v11, v46, 11, v11
    v_lshl_add_u32 v6, v46, 15, v6
    v_lshl_add_u32 v7, v46, 15, v7
    buffer_load_dwordx4 v223, s[12:15], s44 offen offset:2048 lds
    buffer_load_dwordx4 v224, s[12:15], s44 offen offset:3072 lds
    s_waitcnt vmcnt(8)
    s_barrier
    buffer_atomic_add v4, v244, s[32:35], s93 offen sc1
    ds_read_b64_tr_b16 a[128:129], v240 offset:0
    ds_read_b64_tr_b16 a[130:131], v240 offset:512
    ds_read_b64_tr_b16 a[132:133], v240 offset:6144
    ds_read_b64_tr_b16 a[134:135], v240 offset:6656
    ds_read_b64_tr_b16 a[136:137], v240 offset:12288
    ds_read_b64_tr_b16 a[138:139], v240 offset:12800
    ds_read_b64_tr_b16 a[140:141], v240 offset:18432
    ds_read_b64_tr_b16 a[142:143], v240 offset:18944
    ds_read_b64_tr_b16 a[144:145], v241 offset:4096
    ds_read_b64_tr_b16 a[146:147], v241 offset:4608
    ds_read_b64_tr_b16 a[148:149], v242 offset:4096
    ds_read_b64_tr_b16 a[150:151], v242 offset:4608
    s_add_u32 s44, s66, 131072
    s_add_u32 m0, s67, 32768
    s_and_b32 s44, s44, 0x7ffff
    buffer_load_dwordx4 v221, s[12:15], s44 offen offset:0 lds
    buffer_load_dwordx4 v222, s[12:15], s44 offen offset:1024 lds
    buffer_load_dwordx4 v223, s[12:15], s44 offen offset:2048 lds
    buffer_load_dwordx4 v224, s[12:15], s44 offen offset:3072 lds
    s_add_u32 s44, s66, 196608
    s_add_u32 m0, s67, 49152
    s_and_b32 s44, s44, 0x7ffff
    buffer_load_dwordx4 v221, s[12:15], s44 offen offset:0 lds
    buffer_load_dwordx4 v222, s[12:15], s44 offen offset:1024 lds
    buffer_load_dwordx4 v223, s[12:15], s44 offen offset:2048 lds
    buffer_load_dwordx4 v224, s[12:15], s44 offen offset:3072 lds
    v_add_u32 v252, 0x2000, v2
    s_waitcnt lgkmcnt(8)
    v_mfma_f32_16x16x32_bf16 v[248:251], v[16:19], a[128:131], 0
    buffer_store_dwordx4 a[128:131], v2, s[32:35], s87 offen offset:0 sc1
    v_mfma_f32_16x16x32_bf16 v[248:251], v[16:19], a[132:135], v[248:251]
    buffer_store_dwordx4 a[132:135], v2, s[32:35], s87 offen offset:1024 sc1
    s_waitcnt lgkmcnt(4)
    v_mfma_f32_16x16x32_bf16 v[248:251], v[16:19], a[136:139], v[248:251]
    buffer_store_dwordx4 a[136:139], v2, s[32:35], s87 offen offset:2048 sc1
    v_mfma_f32_16x16x32_bf16 v[248:251], v[16:19], a[140:143], v[248:251]
    buffer_store_dwordx4 a[140:143], v2, s[32:35], s87 offen offset:3072 sc1
    s_nop 6
    buffer_atomic_add_f32 v248, v243, s[32:35], s89 offen
    s_add_u32 s93, s93, 4096
    s_add_u32 s44, s66, 262144
    s_add_u32 m0, s67, 65536
    s_and_b32 s44, s44, 0x7ffff
    buffer_load_dwordx4 v221, s[12:15], s44 offen offset:0 lds
    buffer_load_dwordx4 v222, s[12:15], s44 offen offset:1024 lds
    buffer_load_dwordx4 v223, s[12:15], s44 offen offset:2048 lds
    buffer_load_dwordx4 v224, s[12:15], s44 offen offset:3072 lds
    s_add_u32 s44, s66, 327680
    s_add_u32 m0, s67, 81920
    s_and_b32 s44, s44, 0x7ffff
    buffer_load_dwordx4 v221, s[12:15], s44 offen offset:0 lds
    buffer_load_dwordx4 v222, s[12:15], s44 offen offset:1024 lds
    buffer_load_dwordx4 v223, s[12:15], s44 offen offset:2048 lds
    buffer_load_dwordx4 v224, s[12:15], s44 offen offset:3072 lds
    s_add_u32 s44, s66, 393216
    s_add_u32 m0, s67, 98304
    s_and_b32 s44, s44, 0x7ffff
    buffer_load_dwordx4 v221, s[12:15], s44 offen offset:0 lds
    buffer_load_dwordx4 v222, s[12:15], s44 offen offset:1024 lds
    buffer_load_dwordx4 v223, s[12:15], s44 offen offset:2048 lds
    buffer_load_dwordx4 v224, s[12:15], s44 offen offset:3072 lds
    s_waitcnt vmcnt(12)
    s_barrier
    buffer_atomic_add v4, v244, s[32:35], s93 offen sc1
    ds_read_b64_tr_b16 a[0:1], v225 offset:0
    ds_read_b64_tr_b16 a[2:3], v225 offset:1024
    ds_read_b64_tr_b16 a[4:5], v225 offset:4096
    ds_read_b64_tr_b16 a[6:7], v225 offset:5120
    ds_read_b64_tr_b16 a[8:9], v225 offset:8192
    ds_read_b64_tr_b16 a[10:11], v225 offset:9216
    ds_read_b64_tr_b16 a[12:13], v225 offset:12288
    ds_read_b64_tr_b16 a[14:15], v225 offset:13312
    ds_read_b64_tr_b16 a[16:17], v226 offset:0
    ds_read_b64_tr_b16 a[18:19], v226 offset:1024
    ds_read_b64_tr_b16 a[20:21], v226 offset:4096
    s_waitcnt lgkmcnt(14)
    ds_read_b64_tr_b16 a[22:23], v226 offset:5120
    s_waitcnt lgkmcnt(14)
    ds_read_b64_tr_b16 a[24:25], v226 offset:8192
    s_waitcnt lgkmcnt(14)
    ds_read_b64_tr_b16 a[26:27], v226 offset:9216
    s_waitcnt lgkmcnt(14)
    ds_read_b64_tr_b16 a[28:29], v226 offset:12288
    s_waitcnt lgkmcnt(14)
    ds_read_b64_tr_b16 a[30:31], v226 offset:13312
    s_waitcnt lgkmcnt(14)
    ds_read_b64_tr_b16 a[32:33], v227 offset:0
    s_waitcnt lgkmcnt(14)
    ds_read_b64_tr_b16 a[34:35], v227 offset:1024
    s_waitcnt lgkmcnt(14)
    ds_read_b64_tr_b16 a[36:37], v227 offset:4096
    s_waitcnt lgkmcnt(14)
    ds_read_b64_tr_b16 a[38:39], v227 offset:5120
    s_waitcnt lgkmcnt(14)
    ds_read_b64_tr_b16 a[40:41], v227 offset:8192
    s_waitcnt lgkmcnt(14)
    ds_read_b64_tr_b16 a[42:43], v227 offset:9216
    s_waitcnt lgkmcnt(14)
    ds_read_b64_tr_b16 a[44:45], v227 offset:12288
    s_waitcnt lgkmcnt(14)
    ds_read_b64_tr_b16 a[46:47], v227 offset:13312
    s_waitcnt lgkmcnt(14)
    ds_read_b64_tr_b16 a[48:49], v228 offset:0
    s_waitcnt lgkmcnt(14)
    ds_read_b64_tr_b16 a[50:51], v228 offset:1024
    s_waitcnt lgkmcnt(14)
    ds_read_b64_tr_b16 a[52:53], v228 offset:4096
    s_waitcnt lgkmcnt(14)
    ds_read_b64_tr_b16 a[54:55], v228 offset:5120
    s_waitcnt lgkmcnt(14)
    ds_read_b64_tr_b16 a[56:57], v228 offset:8192
    s_waitcnt lgkmcnt(14)
    ds_read_b64_tr_b16 a[58:59], v228 offset:9216
    s_waitcnt lgkmcnt(14)
    ds_read_b64_tr_b16 a[60:61], v228 offset:12288
    s_waitcnt lgkmcnt(14)
    ds_read_b64_tr_b16 a[62:63], v228 offset:13312
    s_lshr_b32 s46, s25, 3
    s_lshl_b32 s46, s46, 1
    s_add_u32 s45, s45, s46
    s_lshl_b32 s81, s45, 18
    s_lshl_b32 s46, s40, 16
    s_add_u32 s81, s81, s46
    s_add_u32 s81, s81, 0x1000000
    s_xor_b32 s81, s81, s98
    s_lshr_b32 s46, s40, 1
    s_add_u32 s45, s45, s46
    s_lshl_b32 s46, s46, 18
    s_lshl_b32 s45, s45, 15
    v_add_u32 v225, 0x10000, v225
    v_add_u32 v226, 0x10000, v226
    v_add_u32 v227, 0x10000, v227
    v_add_u32 v228, 0x10000, v228
    v_add_u32 v12, 0x10000, v10
    v_add_u32 v13, 0x10000, v11
    v_and_b32 v14, 0x7c, v3
    v_add_u32 v15, s46, v45
    v_lshl_add_u32 v15, v46, 14, v15
    v_xor_b32 v42, 0x40000, v15
    s_lshl_b32 s46, s53, 1
    s_add_u32 s46, s46, s47
    s_lshl_b32 s82, s46, 6
    s_add_u32 s82, s82, s45
    s_lshr_b32 s78, s46, 2
    s_lshl_b32 s78, s78, 13
    s_add_u32 s78, s78, s45
    s_and_b32 s46, s46, 3
    s_lshl_b32 s46, s46, 10
    s_add_u32 s78, s78, s46
    s_lshl_b32 s78, s78, 1
    s_add_u32 s78, s78, 0x800000
    s_xor_b32 s78, s78, s97
    s_add_u32 s4, s81, 7168
    s_add_u32 s5, s4, 0x40000
    s_and_b32 s47, s25, 3
    s_mul_i32 s47, s47, 16380
    s_sub_u32 s6, s83, s47
    s_cmp_lg_u32 s40, 1
    s_cbranch_scc1 L_pd_9
    s_mov_b32 s59, 0
    s_mov_b64 exec, 0xffff
L_pl_8:
    buffer_load_dword v5, v236, s[32:35], s20 offen sc1
    s_add_u32 s59, s59, 1
    s_waitcnt vmcnt(0)
    v_cmp_gt_u32 vcc, 16, v5
    s_cmp_ge_u32 s59, 0x8000
    s_nop 0
    s_cselect_b64 vcc, 0, vcc
    s_nop 0
    s_and_b64 exec, exec, vcc
    s_cbranch_scc1 L_pl_8
    s_mov_b64 exec, -1
L_pd_9:
    s_waitcnt lgkmcnt(0)
    s_barrier
    buffer_load_dwordx2 v[32:33], v41, s[32:35], s91 offen sc1
    buffer_load_dwordx4 v[48:51], v2, s[32:35], s90 offen offset:0 sc1
    buffer_load_dwordx4 v[52:55], v2, s[32:35], s90 offen offset:1024 sc1
    buffer_load_dwordx4 a[224:227], v2, s[32:35], s92 offen offset:0 sc1
    buffer_load_dwordx4 a[228:231], v2, s[32:35], s92 offen offset:1024 sc1
    buffer_load_dwordx4 v[56:59], v2, s[32:35], s90 offen offset:2048 sc1
    buffer_load_dwordx4 v[60:63], v2, s[32:35], s90 offen offset:3072 sc1
    buffer_load_dwordx4 a[232:235], v2, s[32:35], s92 offen offset:2048 sc1
    buffer_load_dwordx4 a[236:239], v2, s[32:35], s92 offen offset:3072 sc1
    s_waitcnt vmcnt(8)
    v_cvt_pk_bf16_f32 v32, v32, v33
    ds_write_b32 v234, v32
    ds_read_b128 v[96:99], v235 offset:0
    ds_read_b128 v[100:103], v235 offset:64
    ds_read_b128 v[104:107], v235 offset:128
    ds_read_b128 v[108:111], v235 offset:192
    buffer_load_dwordx4 v[64:67], v2, s[32:35], s18 offen offset:0 sc1
    buffer_load_dwordx4 v[68:71], v2, s[32:35], s18 offen offset:1024 sc1
    buffer_load_dwordx4 a[240:243], v2, s[32:35], s19 offen offset:0 sc1
    buffer_load_dwordx4 a[244:247], v2, s[32:35], s19 offen offset:1024 sc1
    s_waitcnt vmcnt(11)
    v_cvt_pk_bf16_f32 v80, v48, v49
    v_cvt_pk_bf16_f32 v81, v50, v51
    s_waitcnt vmcnt(10)
    v_cvt_pk_bf16_f32 v82, v52, v53
    v_cvt_pk_bf16_f32 v83, v54, v55
    s_waitcnt lgkmcnt(3)
    v_cndmask_b32 v112, v80, v96, s[64:65]
    v_cndmask_b32 v113, v81, v97, s[64:65]
    v_cndmask_b32 v114, v82, v98, s[64:65]
    v_cndmask_b32 v115, v83, v99, s[64:65]
    v_cndmask_b32 v116, v96, v80, s[64:65]
    v_cndmask_b32 v117, v97, v81, s[64:65]
    v_cndmask_b32 v118, v98, v82, s[64:65]
    v_cndmask_b32 v119, v99, v83, s[64:65]
    s_waitcnt vmcnt(9)
    v_mfma_f32_32x32x16_bf16 v[144:159], v[112:115], a[224:227], 0
    s_waitcnt vmcnt(8)
    v_mfma_f32_32x32x16_bf16 v[160:175], v[116:119], a[228:231], 0
    s_waitcnt vmcnt(7)
    v_cvt_pk_bf16_f32 v84, v56, v57
    v_cvt_pk_bf16_f32 v85, v58, v59
    s_waitcnt vmcnt(6)
    v_cvt_pk_bf16_f32 v86, v60, v61
    v_cvt_pk_bf16_f32 v87, v62, v63
    s_waitcnt lgkmcnt(2)
    v_cndmask_b32 v120, v84, v100, s[64:65]
    v_cndmask_b32 v121, v85, v101, s[64:65]
    v_cndmask_b32 v122, v86, v102, s[64:65]
    v_cndmask_b32 v123, v87, v103, s[64:65]
    v_cndmask_b32 v124, v100, v84, s[64:65]
    v_cndmask_b32 v125, v101, v85, s[64:65]
    v_cndmask_b32 v126, v102, v86, s[64:65]
    v_cndmask_b32 v127, v103, v87, s[64:65]
    s_waitcnt vmcnt(5)
    v_mfma_f32_32x32x16_bf16 v[176:191], v[120:123], a[232:235], 0
    buffer_load_dwordx4 v[72:75], v2, s[32:35], s18 offen offset:2048 sc1
    buffer_load_dwordx4 v[76:79], v2, s[32:35], s18 offen offset:3072 sc1
    buffer_load_dwordx4 a[248:251], v2, s[32:35], s19 offen offset:2048 sc1
    v_add_f32 v152, s61, v152
    v_rcp_f32 v152, v152
    s_nop 0
    v_mul_f32 v144, v144, v152
    v_mul_f32 v145, v145, v152
    v_mul_f32 v146, v146, v152
    v_mul_f32 v147, v147, v152
    v_mul_f32 v148, v148, v152
    v_mul_f32 v149, v149, v152
    v_mul_f32 v150, v150, v152
    v_mul_f32 v151, v151, v152
    v_cvt_pk_bf16_f32 v48, v144, v145
    v_cvt_pk_bf16_f32 v49, v146, v147
    v_cvt_pk_bf16_f32 v50, v148, v149
    v_cvt_pk_bf16_f32 v51, v150, v151
    s_waitcnt vmcnt(7)
    v_mfma_f32_32x32x16_bf16 v[144:159], v[124:127], a[236:239], 0
    ds_write_b128 v229, v[48:51] offset:0
    buffer_load_dwordx4 a[252:255], v2, s[32:35], s19 offen offset:3072 sc1
    s_add_u32 s44, s66, 458752
    s_add_u32 m0, s67, 114688
    s_and_b32 s44, s44, 0x7ffff
    buffer_load_dwordx4 v221, s[12:15], s44 offen offset:0 lds
    buffer_load_dwordx4 v222, s[12:15], s44 offen offset:1024 lds
    v_add_f32 v160, s61, v160
    v_rcp_f32 v160, v160
    s_nop 0
    v_mul_f32 v168, v168, v160
    v_mul_f32 v169, v169, v160
    v_mul_f32 v170, v170, v160
    v_mul_f32 v171, v171, v160
    v_mul_f32 v172, v172, v160
    v_mfma_f32_32x32x16_bf16 v[192:207], a[0:3], v[48:51], v[192:207]
    v_mul_f32 v173, v173, v160
    v_mul_f32 v174, v174, v160
    v_mul_f32 v175, v175, v160
    v_cvt_pk_bf16_f32 v52, v168, v169
    v_cvt_pk_bf16_f32 v53, v170, v171
    v_cvt_pk_bf16_f32 v54, v172, v173
    v_cvt_pk_bf16_f32 v55, v174, v175
    s_waitcnt vmcnt(9)
    v_cvt_pk_bf16_f32 v88, v64, v65
    v_cvt_pk_bf16_f32 v89, v66, v67
    s_waitcnt vmcnt(8)
    v_cvt_pk_bf16_f32 v90, v68, v69
    v_cvt_pk_bf16_f32 v91, v70, v71
    s_waitcnt lgkmcnt(2)
    v_cndmask_b32 v128, v88, v104, s[64:65]
    v_cndmask_b32 v129, v89, v105, s[64:65]
    v_cndmask_b32 v130, v90, v106, s[64:65]
    v_cndmask_b32 v131, v91, v107, s[64:65]
    v_cndmask_b32 v132, v104, v88, s[64:65]
    v_cndmask_b32 v133, v105, v89, s[64:65]
    v_cndmask_b32 v134, v106, v90, s[64:65]
    v_cndmask_b32 v135, v107, v91, s[64:65]
    s_waitcnt vmcnt(7)
    v_mfma_f32_32x32x16_bf16 v[160:175], v[128:131], a[240:243], 0
    ds_write_b128 v229, v[52:55] offset:1024
    buffer_load_dwordx4 v223, s[12:15], s44 offen offset:2048 lds
    buffer_load_dwordx4 v224, s[12:15], s44 offen offset:3072 lds
    v_add_f32 v184, s61, v184
    v_rcp_f32 v184, v184
    s_nop 0
    v_mul_f32 v176, v176, v184
    v_mul_f32 v177, v177, v184
    v_mul_f32 v178, v178, v184
    v_mul_f32 v179, v179, v184
    v_mul_f32 v180, v180, v184
    v_mfma_f32_32x32x16_bf16 v[192:207], a[4:7], v[52:55], v[192:207]
    v_mul_f32 v181, v181, v184
    v_mul_f32 v182, v182, v184
    v_mul_f32 v183, v183, v184
    v_cvt_pk_bf16_f32 v56, v176, v177
    v_cvt_pk_bf16_f32 v57, v178, v179
    v_cvt_pk_bf16_f32 v58, v180, v181
    v_cvt_pk_bf16_f32 v59, v182, v183
    s_waitcnt vmcnt(8)
    v_mfma_f32_32x32x16_bf16 v[176:191], v[132:135], a[244:247], 0
    ds_write_b128 v229, v[56:59] offset:2048
    buffer_load_dword v5, v236, s[32:35], s21 offen sc1
    buffer_store_dwordx4 a[128:131], v2, s[32:35], s1 offen offset:0 sc1
    buffer_store_dwordx4 a[132:135], v2, s[32:35], s1 offen offset:1024 sc1
    v_add_f32 v144, s61, v144
    v_rcp_f32 v144, v144
    s_nop 0
    v_mul_f32 v152, v152, v144
    v_mul_f32 v153, v153, v144
    v_mul_f32 v154, v154, v144
    v_mul_f32 v155, v155, v144
    v_mul_f32 v156, v156, v144
    v_mfma_f32_32x32x16_bf16 v[192:207], a[8:11], v[56:59], v[192:207]
    v_mul_f32 v157, v157, v144
    v_mul_f32 v158, v158, v144
    v_mul_f32 v159, v159, v144
    v_cvt_pk_bf16_f32 v60, v152, v153
    v_cvt_pk_bf16_f32 v61, v154, v155
    v_cvt_pk_bf16_f32 v62, v156, v157
    v_cvt_pk_bf16_f32 v63, v158, v159
    s_waitcnt vmcnt(10)
    v_cvt_pk_bf16_f32 v92, v72, v73
    v_cvt_pk_bf16_f32 v93, v74, v75
    s_waitcnt vmcnt(9)
    v_cvt_pk_bf16_f32 v94, v76, v77
    v_cvt_pk_bf16_f32 v95, v78, v79
    s_waitcnt lgkmcnt(3)
    v_cndmask_b32 v136, v92, v108, s[64:65]
    v_cndmask_b32 v137, v93, v109, s[64:65]
    v_cndmask_b32 v138, v94, v110, s[64:65]
    v_cndmask_b32 v139, v95, v111, s[64:65]
    v_cndmask_b32 v140, v108, v92, s[64:65]
    v_cndmask_b32 v141, v109, v93, s[64:65]
    v_cndmask_b32 v142, v110, v94, s[64:65]
    v_cndmask_b32 v143, v111, v95, s[64:65]
    s_waitcnt vmcnt(8)
    v_mfma_f32_32x32x16_bf16 v[144:159], v[136:139], a[248:251], 0
    ds_write_b128 v229, v[60:63] offset:3072
    buffer_store_dwordx4 a[136:139], v2, s[32:35], s1 offen offset:2048 sc1
    buffer_store_dwordx4 a[140:143], v2, s[32:35], s1 offen offset:3072 sc1
    v_add_f32 v168, s61, v168
    v_rcp_f32 v168, v168
    s_nop 0
    v_mul_f32 v160, v160, v168
    v_mul_f32 v161, v161, v168
    v_mul_f32 v162, v162, v168
    v_mul_f32 v163, v163, v168
    v_mul_f32 v164, v164, v168
    v_mfma_f32_32x32x16_bf16 v[192:207], a[12:15], v[60:63], v[192:207]
    v_mul_f32 v165, v165, v168
    v_mul_f32 v166, v166, v168
    v_mul_f32 v167, v167, v168
    v_cvt_pk_bf16_f32 v64, v160, v161
    v_cvt_pk_bf16_f32 v65, v162, v163
    v_cvt_pk_bf16_f32 v66, v164, v165
    v_cvt_pk_bf16_f32 v67, v166, v167
    s_waitcnt vmcnt(9)
    v_mfma_f32_32x32x16_bf16 v[160:175], v[140:143], a[252:255], 0
    ds_write_b128 v229, v[64:67] offset:16384
    s_waitcnt lgkmcnt(1)
    s_barrier
    ds_read_b128 v[208:211], v230 offset:0
    ds_read_b128 v[248:251], v230 offset:1024
    ds_read_b128 v[16:19], v230 offset:2048
    ds_read_b128 v[20:23], v230 offset:3072
    ds_read_b128 v[36:39], v231 offset:0
    buffer_store_dwordx4 a[144:147], v2, s[32:35], s88 offen sc1
    buffer_store_dwordx4 a[148:151], v2, s[32:35], s88 offen offset:1024 sc1
    v_add_f32 v176, s61, v176
    v_rcp_f32 v176, v176
    s_nop 0
    v_mul_f32 v184, v184, v176
    v_mul_f32 v185, v185, v176
    v_mul_f32 v186, v186, v176
    v_mul_f32 v187, v187, v176
    v_mul_f32 v188, v188, v176
    v_mul_f32 v189, v189, v176
    s_waitcnt lgkmcnt(3)
    v_mfma_f32_32x32x16_bf16 v[192:207], a[16:19], v[208:211], v[192:207]
    ds_read_b128 v[44:47], v231 offset:1024
    v_mul_f32 v190, v190, v176
    v_mul_f32 v191, v191, v176
    v_cvt_pk_bf16_f32 v68, v184, v185
    v_cvt_pk_bf16_f32 v69, v186, v187
    v_cvt_pk_bf16_f32 v70, v188, v189
    v_cvt_pk_bf16_f32 v71, v190, v191
    v_mfma_f32_32x32x16_bf16 v[192:207], a[20:23], v[248:251], v[192:207]
    ds_read_b128 v[208:211], v231 offset:2048
    ds_write_b128 v229, v[68:71] offset:17408
    buffer_store_dwordx4 a[144:147], v252, s[32:35], s88 offen sc1
    buffer_store_dwordx4 a[148:151], v252, s[32:35], s88 offen offset:1024 sc1
    v_add_f32 v152, s61, v152
    v_rcp_f32 v152, v152
    s_waitcnt lgkmcnt(4)
    v_mfma_f32_32x32x16_bf16 v[192:207], a[24:27], v[16:19], v[192:207]
    ds_read_b128 v[248:251], v231 offset:3072
    v_mul_f32 v144, v144, v152
    v_mul_f32 v145, v145, v152
    v_mul_f32 v146, v146, v152
    v_mul_f32 v147, v147, v152
    v_mfma_f32_32x32x16_bf16 v[192:207], a[28:31], v[20:23], v[192:207]
    ds_read_b128 v[16:19], v232 offset:0
    v_mul_f32 v148, v148, v152
    v_mul_f32 v149, v149, v152
    v_mul_f32 v150, v150, v152
    v_mul_f32 v151, v151, v152
    s_waitcnt lgkmcnt(4)
    v_mfma_f32_32x32x16_bf16 v[192:207], a[32:35], v[36:39], v[192:207]
    ds_read_b128 v[20:23], v232 offset:1024
    v_cvt_pk_bf16_f32 v72, v144, v145
    v_cvt_pk_bf16_f32 v73, v146, v147
    v_cvt_pk_bf16_f32 v74, v148, v149
    v_cvt_pk_bf16_f32 v75, v150, v151
    v_mfma_f32_32x32x16_bf16 v[192:207], a[36:39], v[44:47], v[192:207]
    ds_read_b128 v[36:39], v232 offset:2048
    ds_write_b128 v229, v[72:75] offset:18432
    v_add_f32 v160, s61, v160
    v_rcp_f32 v160, v160
    s_waitcnt lgkmcnt(4)
    v_mfma_f32_32x32x16_bf16 v[192:207], a[40:43], v[208:211], v[192:207]
    ds_read_b128 v[44:47], v232 offset:3072
    v_mul_f32 v168, v168, v160
    v_mul_f32 v169, v169, v160
    v_mul_f32 v170, v170, v160
    v_mul_f32 v171, v171, v160
    v_mfma_f32_32x32x16_bf16 v[192:207], a[44:47], v[248:251], v[192:207]
    v_mul_f32 v172, v172, v160
    v_mul_f32 v173, v173, v160
    v_mul_f32 v174, v174, v160
    v_mul_f32 v175, v175, v160
    s_waitcnt lgkmcnt(3)
    v_mfma_f32_32x32x16_bf16 v[192:207], a[48:51], v[16:19], v[192:207]
    v_cvt_pk_bf16_f32 v76, v168, v169
    v_cvt_pk_bf16_f32 v77, v170, v171
    v_cvt_pk_bf16_f32 v78, v172, v173
    v_cvt_pk_bf16_f32 v79, v174, v175
    v_mfma_f32_32x32x16_bf16 v[192:207], a[52:55], v[20:23], v[192:207]
    ds_write_b128 v229, v[76:79] offset:19456
    s_waitcnt lgkmcnt(3)
    v_mfma_f32_32x32x16_bf16 v[192:207], a[56:59], v[36:39], v[192:207]
    s_waitcnt vmcnt(9) lgkmcnt(0)
    s_barrier
    ds_read_b64_tr_b16 a[64:65], v225 offset:0
    ds_read_b64_tr_b16 a[66:67], v225 offset:1024
    ds_read_b64_tr_b16 a[68:69], v225 offset:4096
    ds_read_b64_tr_b16 a[70:71], v225 offset:5120
    ds_read_b64_tr_b16 a[72:73], v225 offset:8192
    ds_read_b64_tr_b16 a[74:75], v225 offset:9216
    ds_read_b64_tr_b16 a[76:77], v225 offset:12288
    ds_read_b64_tr_b16 a[78:79], v225 offset:13312
    v_mfma_f32_32x32x16_bf16 v[192:207], a[60:63], v[44:47], v[192:207]
    ds_read_b64_tr_b16 a[80:81], v226 offset:0
    ds_read_b64_tr_b16 a[82:83], v226 offset:1024
    ds_read_b128 v[96:99], v230 offset:16384
    s_waitcnt vmcnt(8)
    v_cmp_gt_u32 vcc, 16, v5
    s_nop 0
    s_and_b64 vcc, vcc, 0xffff
    s_cbranch_scc1 L_o_11
L_r_12:
    s_waitcnt lgkmcnt(7)
    v_mfma_f32_32x32x16_bf16 v[192:207], a[64:67], v[64:67], v[192:207]
    ds_read_b64_tr_b16 a[84:85], v226 offset:4096
    ds_read_b64_tr_b16 a[86:87], v226 offset:5120
    ds_read_b128 v[100:103], v230 offset:17408
    s_add_u32 m0, s17, 0
    s_add_u32 s44, s16, 0
    buffer_load_dwordx4 v2, s[32:35], s44 offen offset:0 sc1 lds
    v_mfma_f32_32x32x16_bf16 v[192:207], a[68:71], v[68:71], v[192:207]
    ds_read_b64_tr_b16 a[88:89], v226 offset:8192
    ds_read_b64_tr_b16 a[90:91], v226 offset:9216
    ds_read_b128 v[104:107], v230 offset:18432
    s_waitcnt lgkmcnt(9)
    v_mfma_f32_32x32x16_bf16 v[192:207], a[72:75], v[72:75], v[192:207]
    ds_read_b64_tr_b16 a[92:93], v226 offset:12288
    ds_read_b64_tr_b16 a[94:95], v226 offset:13312
    ds_read_b128 v[108:111], v230 offset:19456
    buffer_load_dwordx4 v2, s[32:35], s44 offen offset:1024 sc1 lds
    v_mfma_f32_32x32x16_bf16 v[192:207], a[76:79], v[76:79], v[192:207]
    ds_read_b64_tr_b16 a[96:97], v227 offset:0
    ds_read_b64_tr_b16 a[98:99], v227 offset:1024
    ds_read_b128 v[80:83], v231 offset:16384
    s_waitcnt lgkmcnt(12)
    v_mfma_f32_32x32x16_bf16 v[192:207], a[80:83], v[96:99], v[192:207]
    ds_read_b64_tr_b16 a[100:101], v227 offset:4096
    ds_read_b64_tr_b16 a[102:103], v227 offset:5120
    ds_read_b128 v[84:87], v231 offset:17408
    buffer_load_dwordx4 v2, s[32:35], s44 offen offset:2048 sc1 lds
    s_waitcnt lgkmcnt(12)
    v_mfma_f32_32x32x16_bf16 v[192:207], a[84:87], v[100:103], v[192:207]
    ds_read_b64_tr_b16 a[104:105], v227 offset:8192
    ds_read_b64_tr_b16 a[106:107], v227 offset:9216
    ds_read_b128 v[88:91], v231 offset:18432
    s_waitcnt lgkmcnt(12)
    v_mfma_f32_32x32x16_bf16 v[192:207], a[88:91], v[104:107], v[192:207]
    ds_read_b64_tr_b16 a[108:109], v227 offset:12288
    ds_read_b64_tr_b16 a[110:111], v227 offset:13312
    ds_read_b128 v[92:95], v231 offset:19456
    buffer_load_dwordx4 v2, s[32:35], s44 offen offset:3072 sc1 lds
    s_waitcnt lgkmcnt(12)
    v_mfma_f32_32x32x16_bf16 v[192:207], a[92:95], v[108:111], v[192:207]
    ds_read_b64_tr_b16 a[112:113], v228 offset:0
    ds_read_b64_tr_b16 a[114:115], v228 offset:1024
    ds_read_b128 v[96:99], v232 offset:16384
    s_waitcnt lgkmcnt(12)
    v_mfma_f32_32x32x16_bf16 v[192:207], a[96:99], v[80:83], v[192:207]
    ds_read_b64_tr_b16 a[116:117], v228 offset:4096
    ds_read_b64_tr_b16 a[118:119], v228 offset:5120
    ds_read_b128 v[100:103], v232 offset:17408
    s_add_u32 m0, s17, 4096
    s_add_u32 s44, s16, 4096
    buffer_load_dwordx4 v2, s[32:35], s44 offen offset:0 sc1 lds
    s_waitcnt lgkmcnt(12)
    v_mfma_f32_32x32x16_bf16 v[192:207], a[100:103], v[84:87], v[192:207]
    ds_read_b64_tr_b16 a[120:121], v228 offset:8192
    ds_read_b64_tr_b16 a[122:123], v228 offset:9216
    ds_read_b128 v[104:107], v232 offset:18432
    s_waitcnt lgkmcnt(12)
    v_mfma_f32_32x32x16_bf16 v[192:207], a[104:107], v[88:91], v[192:207]
    ds_read_b64_tr_b16 a[124:125], v228 offset:12288
    ds_read_b64_tr_b16 a[126:127], v228 offset:13312
    ds_read_b128 v[108:111], v232 offset:19456
    buffer_load_dwordx4 v2, s[32:35], s44 offen offset:1024 sc1 lds
    s_waitcnt lgkmcnt(12)
    v_mfma_f32_32x32x16_bf16 v[192:207], a[108:111], v[92:95], v[192:207]
    s_waitcnt lgkmcnt(9)
    v_mfma_f32_32x32x16_bf16 v[192:207], a[112:115], v[96:99], v[192:207]
    buffer_load_dwordx4 v2, s[32:35], s44 offen offset:2048 sc1 lds
    s_waitcnt lgkmcnt(6)
    v_mfma_f32_32x32x16_bf16 v[192:207], a[116:119], v[100:103], v[192:207]
    s_waitcnt lgkmcnt(3)
    v_mfma_f32_32x32x16_bf16 v[192:207], a[120:123], v[104:107], v[192:207]
    buffer_load_dwordx4 v2, s[32:35], s44 offen offset:3072 sc1 lds
    s_waitcnt lgkmcnt(0)
    v_mfma_f32_32x32x16_bf16 v[192:207], a[124:127], v[108:111], v[192:207]
    s_nop 11
    v_cvt_pk_bf16_f32 v48, v192, v193
    v_cvt_pk_bf16_f32 v49, v194, v195
    v_cvt_pk_bf16_f32 v50, v196, v197
    v_cvt_pk_bf16_f32 v51, v198, v199
    buffer_store_dwordx4 v[48:51], v2, s[32:35], s94 offen sc1
    v_cvt_pk_bf16_f32 v52, v200, v201
    v_cvt_pk_bf16_f32 v53, v202, v203
    v_cvt_pk_bf16_f32 v54, v204, v205
    v_cvt_pk_bf16_f32 v55, v206, v207
    buffer_store_dwordx4 v[52:55], v2, s[32:35], s94 offen offset:1024 sc1
    v_add_f32 v56, v192, v193
    v_mul_f32 v57, v192, v192
    v_add_f32 v58, v194, v195
    v_mul_f32 v59, v193, v193
    v_fmac_f32 v57, v194, v194
    v_fmac_f32 v59, v195, v195
    v_add_f32 v56, v56, v196
    v_fmac_f32 v57, v196, v196
    v_add_f32 v58, v58, v197
    v_fmac_f32 v59, v197, v197
    v_add_f32 v56, v56, v198
    v_fmac_f32 v57, v198, v198
    v_add_f32 v58, v58, v199
    v_fmac_f32 v59, v199, v199
    v_add_f32 v56, v56, v200
    v_fmac_f32 v57, v200, v200
    v_add_f32 v58, v58, v201
    v_fmac_f32 v59, v201, v201
    v_add_f32 v56, v56, v202
    v_fmac_f32 v57, v202, v202
    v_add_f32 v58, v58, v203
    v_fmac_f32 v59, v203, v203
    v_add_f32 v56, v56, v204
    v_fmac_f32 v57, v204, v204
    v_add_f32 v58, v58, v205
    v_fmac_f32 v59, v205, v205
    v_add_f32 v56, v56, v206
    v_fmac_f32 v57, v206, v206
    v_add_f32 v58, v58, v207
    v_fmac_f32 v59, v207, v207
    v_add_f32 v56, v56, v58
    v_add_f32 v57, v57, v59
    s_nop 1
    v_permlane32_swap_b32 v56, v57
    v_add_f32 v56, v56, v57
    buffer_atomic_add_f32 v56, v3, s[32:35], s95 offen
    buffer_load_dword v160, v14, s[32:35], s79 offen offset:0 sc1
    buffer_load_dword v161, v14, s[32:35], s79 offen offset:128 sc1
    buffer_load_dword v162, v14, s[32:35], s79 offen offset:256 sc1
    buffer_load_dword v163, v14, s[32:35], s79 offen offset:384 sc1
    buffer_load_dword v164, v14, s[32:35], s79 offen offset:512 sc1
    buffer_load_dword v165, v14, s[32:35], s79 offen offset:640 sc1
    buffer_load_dword v166, v14, s[32:35], s79 offen offset:768 sc1
    s_add_u32 m0, s17, 32768
    s_add_u32 s44, s16, 65536
    buffer_load_dwordx4 v2, s[32:35], s44 offen offset:0 sc1 lds
    buffer_load_dwordx4 v2, s[32:35], s44 offen offset:1024 sc1 lds
    buffer_load_dwordx4 v2, s[32:35], s44 offen offset:2048 sc1 lds
    buffer_load_dwordx4 v2, s[32:35], s44 offen offset:3072 sc1 lds
    s_add_u32 m0, s17, 36864
    s_add_u32 s44, s16, 69632
    buffer_load_dwordx4 v2, s[32:35], s44 offen offset:0 sc1 lds
    buffer_load_dwordx4 v2, s[32:35], s44 offen offset:1024 sc1 lds
    buffer_load_dwordx4 v2, s[32:35], s44 offen offset:2048 sc1 lds
    buffer_load_dwordx4 v2, s[32:35], s44 offen offset:3072 sc1 lds
    s_waitcnt vmcnt(15)
    buffer_store_dword v4, v245, s[32:35], s69 offen offset:512 sc1
    s_barrier
    buffer_atomic_add v4, v244, s[32:35], s93 offen offset:128 sc1
    s_add_u32 m0, s17, 65536
    s_add_u32 s44, s22, 131072
    buffer_load_dwordx4 v2, s[32:35], s44 offen offset:0 sc1 lds
    buffer_load_dwordx4 v2, s[32:35], s44 offen offset:1024 sc1 lds
    buffer_load_dwordx4 v2, s[32:35], s44 offen offset:2048 sc1 lds
    buffer_load_dwordx4 v2, s[32:35], s44 offen offset:3072 sc1 lds
    s_add_u32 m0, s17, 69632
    s_add_u32 s44, s22, 135168
    buffer_load_dwordx4 v2, s[32:35], s44 offen offset:0 sc1 lds
    buffer_load_dwordx4 v2, s[32:35], s44 offen offset:1024 sc1 lds
    buffer_load_dwordx4 v2, s[32:35], s44 offen offset:2048 sc1 lds
    buffer_load_dwordx4 v2, s[32:35], s44 offen offset:3072 sc1 lds
    s_add_u32 m0, s17, 98304
    s_add_u32 s44, s22, 196608
    buffer_load_dwordx4 v2, s[32:35], s44 offen offset:0 sc1 lds
    buffer_load_dwordx4 v2, s[32:35], s44 offen offset:1024 sc1 lds
    buffer_load_dwordx4 v2, s[32:35], s44 offen offset:2048 sc1 lds
    buffer_load_dwordx4 v2, s[32:35], s44 offen offset:3072 sc1 lds
    s_mov_b64 s[8:9], 0xffff
    v_mov_b32 v169, 0
    v_mov_b32 v221, 0
    v_mov_b32 v170, 0
    v_mov_b32 v222, 0
    v_mov_b32 v171, 0
    v_mov_b32 v223, 0
    v_mov_b32 v173, 0
    v_mov_b32 v225, 0
    v_mov_b32 v174, 0
    v_mov_b32 v226, 0
    v_mov_b32 v175, 0
    v_mov_b32 v227, 0
    v_mov_b32 v177, 0
    v_mov_b32 v229, 0
    v_mov_b32 v178, 0
    v_mov_b32 v230, 0
    v_mov_b32 v179, 0
    v_mov_b32 v231, 0
    s_waitcnt vmcnt(28)
    v_cvt_pk_bf16_f32 v184, v160, v160
    v_lshlrev_b32 v184, 16, v184
    v_sub_f32 v184, v160, v184
    v_cvt_pk_bf16_f32 v160, v160, v184
    s_waitcnt vmcnt(27)
    v_cvt_pk_bf16_f32 v184, v161, v161
    v_lshlrev_b32 v184, 16, v184
    v_sub_f32 v184, v161, v184
    v_cvt_pk_bf16_f32 v161, v161, v184
    s_waitcnt vmcnt(26)
    v_cvt_pk_bf16_f32 v184, v162, v162
    v_lshlrev_b32 v184, 16, v184
    v_sub_f32 v184, v162, v184
    v_cvt_pk_bf16_f32 v162, v162, v184
    s_waitcnt vmcnt(25)
    v_cvt_pk_bf16_f32 v184, v163, v163
    v_lshlrev_b32 v184, 16, v184
    v_sub_f32 v184, v163, v184
    v_cvt_pk_bf16_f32 v163, v163, v184
    s_waitcnt vmcnt(24)
    v_cvt_pk_bf16_f32 v184, v164, v164
    v_lshlrev_b32 v184, 16, v184
    v_sub_f32 v184, v164, v184
    v_cvt_pk_bf16_f32 v164, v164, v184
    s_waitcnt vmcnt(23)
    v_cvt_pk_bf16_f32 v184, v165, v165
    v_lshlrev_b32 v184, 16, v184
    v_sub_f32 v184, v165, v184
    v_cvt_pk_bf16_f32 v165, v165, v184
    s_waitcnt vmcnt(22)
    v_cvt_pk_bf16_f32 v184, v166, v166
    v_lshlrev_b32 v184, 16, v184
    v_sub_f32 v184, v166, v184
    v_cvt_pk_bf16_f32 v166, v166, v184
    v_mov_b32 v213, v160
    v_mov_b32 v214, v161
    v_mov_b32 v215, v162
    v_mov_b32 v216, v163
    v_mov_b32 v217, v164
    v_mov_b32 v218, v165
    v_mov_b32 v219, v166
    v_permlane16_swap_b32 v160, v213
    v_permlane16_swap_b32 v161, v214
    v_permlane16_swap_b32 v162, v215
    v_permlane16_swap_b32 v163, v216
    v_permlane16_swap_b32 v164, v217
    v_permlane16_swap_b32 v165, v218
    v_permlane16_swap_b32 v166, v219
    v_mov_b32 v220, v213
    v_mov_b32 v224, v214
    v_mov_b32 v168, v160
    v_mov_b32 v172, v161
    s_mov_b32 s59, 0
    s_mov_b64 exec, 0xffff
L_pl_13:
    buffer_load_dword v5, v43, s[32:35], s7 offen sc1
    s_add_u32 s59, s59, 1
    s_waitcnt vmcnt(0)
    v_cmp_gt_u32 vcc, 1, v5
    s_cmp_ge_u32 s59, 0x8000
    s_nop 0
    s_cselect_b64 vcc, 0, vcc
    s_nop 0
    s_and_b64 exec, exec, vcc
    s_cbranch_scc1 L_pl_13
    s_mov_b64 exec, -1
    s_waitcnt vmcnt(0)
    buffer_load_dwordx4 a[0:3], v212, s[32:35], s75 offen offset:0 sc1
    buffer_load_dwordx4 a[4:7], v212, s[32:35], s75 offen offset:256 sc1
    buffer_load_dwordx4 a[8:11], v212, s[32:35], s75 offen offset:2048 sc1
    buffer_load_dwordx4 a[12:15], v212, s[32:35], s75 offen offset:2304 sc1
    s_add_u32 s75, s75, 4096
    buffer_load_dwordx4 a[16:19], v212, s[32:35], s75 offen offset:0 sc1
    buffer_load_dwordx4 a[20:23], v212, s[32:35], s75 offen offset:256 sc1
    buffer_load_dwordx4 a[24:27], v212, s[32:35], s75 offen offset:2048 sc1
    buffer_load_dwordx4 a[28:31], v212, s[32:35], s75 offen offset:2304 sc1
    s_add_u32 s75, s75, 12288
    buffer_load_dwordx4 a[32:35], v212, s[32:35], s75 offen offset:0 sc1
    buffer_load_dwordx4 a[36:39], v212, s[32:35], s75 offen offset:256 sc1
    s_barrier
    ds_read_b128 v[128:131], v212 offset:0
    ds_read_b128 v[132:135], v212 offset:32768
    ds_read_b128 v[136:139], v212 offset:256
    ds_read_b128 v[140:143], v212 offset:33024
    ds_read_b128 v[144:147], v212 offset:2048
    s_waitcnt vmcnt(9) lgkmcnt(3)
    v_mfma_f32_16x16x32_bf16 v[48:51], v[128:131], a[0:3], 0
    ds_read_b128 v[148:151], v212 offset:34816
    buffer_load_dwordx4 a[40:43], v212, s[32:35], s75 offen offset:2048 sc1
    s_waitcnt vmcnt(9)
    v_mfma_f32_16x16x32_bf16 v[52:55], v[128:131], a[4:7], 0
    v_mfma_f32_16x16x32_bf16 v[64:67], v[132:135], a[0:3], 0
    ds_read_b128 v[152:155], v212 offset:2304
    buffer_load_dword v188, v3, s[32:35], s76 offen sc1
    v_mfma_f32_16x16x32_bf16 v[68:71], v[132:135], a[4:7], 0
    s_waitcnt lgkmcnt(3)
    v_mfma_f32_16x16x32_bf16 v[60:63], v[136:139], a[4:7], 0
    ds_read_b128 v[156:159], v212 offset:35072
    buffer_load_dwordx4 a[44:47], v212, s[32:35], s75 offen offset:2304 sc1
    v_mfma_f32_16x16x32_bf16 v[56:59], v[136:139], a[0:3], 0
    v_mfma_f32_16x16x32_bf16 v[76:79], v[140:143], a[4:7], 0
    ds_read_b128 v[128:131], v212 offset:4096
    s_add_u32 s76, s76, 16384
    v_mfma_f32_16x16x32_bf16 v[72:75], v[140:143], a[0:3], 0
    s_waitcnt vmcnt(10) lgkmcnt(3)
    v_mfma_f32_16x16x32_bf16 v[48:51], v[144:147], a[8:11], v[48:51]
    ds_read_b128 v[132:135], v212 offset:36864
    s_add_u32 s75, s75, 4096
    s_waitcnt vmcnt(9)
    v_mfma_f32_16x16x32_bf16 v[52:55], v[144:147], a[12:15], v[52:55]
    buffer_load_dwordx4 a[48:51], v212, s[32:35], s75 offen offset:0 sc1
    v_mfma_f32_16x16x32_bf16 v[64:67], v[148:151], a[8:11], v[64:67]
    ds_read_b128 v[136:139], v212 offset:4352
    buffer_load_dword v189, v3, s[32:35], s76 offen sc1
    v_mfma_f32_16x16x32_bf16 v[68:71], v[148:151], a[12:15], v[68:71]
    s_waitcnt lgkmcnt(3)
    v_mfma_f32_16x16x32_bf16 v[60:63], v[152:155], a[12:15], v[60:63]
    ds_read_b128 v[140:143], v212 offset:37120
    buffer_load_dwordx4 a[52:55], v212, s[32:35], s75 offen offset:256 sc1
    v_mfma_f32_16x16x32_bf16 v[56:59], v[152:155], a[8:11], v[56:59]
    v_mfma_f32_16x16x32_bf16 v[76:79], v[156:159], a[12:15], v[76:79]
    ds_read_b128 v[144:147], v212 offset:6144
    v_mfma_f32_16x16x32_bf16 v[72:75], v[156:159], a[8:11], v[72:75]
    s_waitcnt vmcnt(11) lgkmcnt(3)
    v_mfma_f32_16x16x32_bf16 v[48:51], v[128:131], a[16:19], v[48:51]
    ds_read_b128 v[148:151], v212 offset:38912
    buffer_load_dwordx4 a[56:59], v212, s[32:35], s75 offen offset:2048 sc1
    s_waitcnt vmcnt(11)
    v_mfma_f32_16x16x32_bf16 v[52:55], v[128:131], a[20:23], v[52:55]
    s_add_u32 s76, s76, 16384
    v_mfma_f32_16x16x32_bf16 v[64:67], v[132:135], a[16:19], v[64:67]
    ds_read_b128 v[152:155], v212 offset:6400
    v_mfma_f32_16x16x32_bf16 v[68:71], v[132:135], a[20:23], v[68:71]
    s_waitcnt lgkmcnt(3)
    v_mfma_f32_16x16x32_bf16 v[60:63], v[136:139], a[20:23], v[60:63]
    ds_read_b128 v[156:159], v212 offset:39168
    buffer_load_dwordx4 a[60:63], v212, s[32:35], s75 offen offset:2304 sc1
    v_mfma_f32_16x16x32_bf16 v[56:59], v[136:139], a[16:19], v[56:59]
    buffer_load_dword v190, v3, s[32:35], s76 offen sc1
    v_mfma_f32_16x16x32_bf16 v[76:79], v[140:143], a[20:23], v[76:79]
    ds_read_b128 v[128:131], v212 offset:8192
    v_mfma_f32_16x16x32_bf16 v[72:75], v[140:143], a[16:19], v[72:75]
    s_waitcnt vmcnt(12) lgkmcnt(3)
    v_mfma_f32_16x16x32_bf16 v[48:51], v[144:147], a[24:27], v[48:51]
    ds_read_b128 v[132:135], v212 offset:40960
    s_add_u32 s75, s75, 12288
    s_waitcnt vmcnt(11)
    v_mfma_f32_16x16x32_bf16 v[52:55], v[144:147], a[28:31], v[52:55]
    buffer_load_dwordx4 a[64:67], v212, s[32:35], s75 offen offset:0 sc1
    s_add_u32 s76, s76, 16384
    v_mfma_f32_16x16x32_bf16 v[64:67], v[148:151], a[24:27], v[64:67]
    ds_read_b128 v[136:139], v212 offset:8448
    v_mfma_f32_16x16x32_bf16 v[68:71], v[148:151], a[28:31], v[68:71]
    s_waitcnt lgkmcnt(3)
    v_mfma_f32_16x16x32_bf16 v[60:63], v[152:155], a[28:31], v[60:63]
    ds_read_b128 v[140:143], v212 offset:41216
    buffer_load_dwordx4 a[68:71], v212, s[32:35], s75 offen offset:256 sc1
    v_mfma_f32_16x16x32_bf16 v[56:59], v[152:155], a[24:27], v[56:59]
    v_mfma_f32_16x16x32_bf16 v[76:79], v[156:159], a[28:31], v[76:79]
    ds_read_b128 v[144:147], v212 offset:10240
    buffer_load_dword v191, v3, s[32:35], s76 offen sc1
    v_mfma_f32_16x16x32_bf16 v[72:75], v[156:159], a[24:27], v[72:75]
    s_waitcnt vmcnt(13) lgkmcnt(3)
    v_mfma_f32_16x16x32_bf16 v[48:51], v[128:131], a[32:35], v[48:51]
    ds_read_b128 v[148:151], v212 offset:43008
    buffer_load_dwordx4 a[72:75], v212, s[32:35], s75 offen offset:2048 sc1
    s_waitcnt vmcnt(13)
    v_mfma_f32_16x16x32_bf16 v[52:55], v[128:131], a[36:39], v[52:55]
    v_mfma_f32_16x16x32_bf16 v[64:67], v[132:135], a[32:35], v[64:67]
    ds_read_b128 v[152:155], v212 offset:10496
    s_add_u32 s76, s76, 16384
    v_mfma_f32_16x16x32_bf16 v[68:71], v[132:135], a[36:39], v[68:71]
    s_waitcnt lgkmcnt(3)
    v_mfma_f32_16x16x32_bf16 v[60:63], v[136:139], a[36:39], v[60:63]
    ds_read_b128 v[156:159], v212 offset:43264
    buffer_load_dwordx4 a[76:79], v212, s[32:35], s75 offen offset:2304 sc1
    v_mfma_f32_16x16x32_bf16 v[56:59], v[136:139], a[32:35], v[56:59]
    v_mfma_f32_16x16x32_bf16 v[76:79], v[140:143], a[36:39], v[76:79]
    ds_read_b128 v[128:131], v212 offset:12288
    v_mfma_f32_16x16x32_bf16 v[72:75], v[140:143], a[32:35], v[72:75]
    s_waitcnt vmcnt(13) lgkmcnt(3)
    v_mfma_f32_16x16x32_bf16 v[48:51], v[144:147], a[40:43], v[48:51]
    ds_read_b128 v[132:135], v212 offset:45056
    s_add_u32 s75, s75, 4096
    s_waitcnt vmcnt(11)
    v_mfma_f32_16x16x32_bf16 v[52:55], v[144:147], a[44:47], v[52:55]
    buffer_load_dwordx4 a[80:83], v212, s[32:35], s75 offen offset:0 sc1
    v_mfma_f32_16x16x32_bf16 v[64:67], v[148:151], a[40:43], v[64:67]
    ds_read_b128 v[136:139], v212 offset:12544
    v_mfma_f32_16x16x32_bf16 v[68:71], v[148:151], a[44:47], v[68:71]
    s_waitcnt lgkmcnt(3)
    v_mfma_f32_16x16x32_bf16 v[60:63], v[152:155], a[44:47], v[60:63]
    ds_read_b128 v[140:143], v212 offset:45312
    buffer_load_dwordx4 a[84:87], v212, s[32:35], s75 offen offset:256 sc1
    v_mfma_f32_16x16x32_bf16 v[56:59], v[152:155], a[40:43], v[56:59]
    s_add_u32 s21, s21, 128
    buffer_load_dword v5, v236, s[32:35], s21 offen sc1
    v_mfma_f32_16x16x32_bf16 v[76:79], v[156:159], a[44:47], v[76:79]
    ds_read_b128 v[144:147], v212 offset:14336
    v_mfma_f32_16x16x32_bf16 v[72:75], v[156:159], a[40:43], v[72:75]
    s_waitcnt vmcnt(13) lgkmcnt(3)
    v_mfma_f32_16x16x32_bf16 v[48:51], v[128:131], a[48:51], v[48:51]
    ds_read_b128 v[148:151], v212 offset:47104
    buffer_load_dwordx4 a[88:91], v212, s[32:35], s75 offen offset:2048 sc1
    s_waitcnt vmcnt(12)
    v_mfma_f32_16x16x32_bf16 v[52:55], v[128:131], a[52:55], v[52:55]
    v_mfma_f32_16x16x32_bf16 v[64:67], v[132:135], a[48:51], v[64:67]
    ds_read_b128 v[152:155], v212 offset:14592
    v_mfma_f32_16x16x32_bf16 v[68:71], v[132:135], a[52:55], v[68:71]
    s_waitcnt lgkmcnt(3)
    v_mfma_f32_16x16x32_bf16 v[60:63], v[136:139], a[52:55], v[60:63]
    ds_read_b128 v[156:159], v212 offset:47360
    buffer_load_dwordx4 a[92:95], v212, s[32:35], s75 offen offset:2304 sc1
    v_mfma_f32_16x16x32_bf16 v[56:59], v[136:139], a[48:51], v[56:59]
    v_mfma_f32_16x16x32_bf16 v[76:79], v[140:143], a[52:55], v[76:79]
    ds_read_b128 v[128:131], v212 offset:16384
    v_mfma_f32_16x16x32_bf16 v[72:75], v[140:143], a[48:51], v[72:75]
    s_waitcnt vmcnt(12) lgkmcnt(3)
    v_mfma_f32_16x16x32_bf16 v[48:51], v[144:147], a[56:59], v[48:51]
    ds_read_b128 v[132:135], v212 offset:49152
    s_add_u32 s75, s75, 12288
    s_waitcnt vmcnt(11)
    v_mfma_f32_16x16x32_bf16 v[52:55], v[144:147], a[60:63], v[52:55]
    buffer_load_dwordx4 a[96:99], v212, s[32:35], s75 offen offset:0 sc1
    v_mfma_f32_16x16x32_bf16 v[64:67], v[148:151], a[56:59], v[64:67]
    ds_read_b128 v[136:139], v212 offset:16640
    v_mfma_f32_16x16x32_bf16 v[68:71], v[148:151], a[60:63], v[68:71]
    s_waitcnt lgkmcnt(3)
    v_mfma_f32_16x16x32_bf16 v[60:63], v[152:155], a[60:63], v[60:63]
    ds_read_b128 v[140:143], v212 offset:49408
    buffer_load_dwordx4 a[100:103], v212, s[32:35], s75 offen offset:256 sc1
    v_mfma_f32_16x16x32_bf16 v[56:59], v[152:155], a[56:59], v[56:59]
    v_mfma_f32_16x16x32_bf16 v[76:79], v[156:159], a[60:63], v[76:79]
    ds_read_b128 v[144:147], v212 offset:18432
    v_mfma_f32_16x16x32_bf16 v[72:75], v[156:159], a[56:59], v[72:75]
    s_waitcnt vmcnt(11) lgkmcnt(3)
    v_mfma_f32_16x16x32_bf16 v[48:51], v[128:131], a[64:67], v[48:51]
    ds_read_b128 v[148:151], v212 offset:51200
    buffer_load_dwordx4 a[104:107], v212, s[32:35], s75 offen offset:2048 sc1
    s_waitcnt vmcnt(11)
    v_mfma_f32_16x16x32_bf16 v[52:55], v[128:131], a[68:71], v[52:55]
    v_mfma_f32_16x16x32_bf16 v[64:67], v[132:135], a[64:67], v[64:67]
    ds_read_b128 v[152:155], v212 offset:18688
    v_mfma_f32_16x16x32_bf16 v[68:71], v[132:135], a[68:71], v[68:71]
    s_waitcnt lgkmcnt(3)
    v_mfma_f32_16x16x32_bf16 v[60:63], v[136:139], a[68:71], v[60:63]
    ds_read_b128 v[156:159], v212 offset:51456
    buffer_load_dwordx4 a[108:111], v212, s[32:35], s75 offen offset:2304 sc1
    v_mfma_f32_16x16x32_bf16 v[56:59], v[136:139], a[64:67], v[56:59]
    v_mfma_f32_16x16x32_bf16 v[76:79], v[140:143], a[68:71], v[76:79]
    ds_read_b128 v[128:131], v212 offset:20480
    v_mfma_f32_16x16x32_bf16 v[72:75], v[140:143], a[64:67], v[72:75]
    s_waitcnt vmcnt(10) lgkmcnt(3)
    v_mfma_f32_16x16x32_bf16 v[48:51], v[144:147], a[72:75], v[48:51]
    ds_read_b128 v[132:135], v212 offset:53248
    s_add_u32 s75, s75, 4096
    s_waitcnt vmcnt(9)
    v_mfma_f32_16x16x32_bf16 v[52:55], v[144:147], a[76:79], v[52:55]
    buffer_load_dwordx4 a[112:115], v212, s[32:35], s75 offen offset:0 sc1
    v_mfma_f32_16x16x32_bf16 v[64:67], v[148:151], a[72:75], v[64:67]
    ds_read_b128 v[136:139], v212 offset:20736
    v_mfma_f32_16x16x32_bf16 v[68:71], v[148:151], a[76:79], v[68:71]
    s_waitcnt lgkmcnt(3)
    v_mfma_f32_16x16x32_bf16 v[60:63], v[152:155], a[76:79], v[60:63]
    ds_read_b128 v[140:143], v212 offset:53504
    buffer_load_dwordx4 a[116:119], v212, s[32:35], s75 offen offset:256 sc1
    v_mfma_f32_16x16x32_bf16 v[56:59], v[152:155], a[72:75], v[56:59]
    v_mfma_f32_16x16x32_bf16 v[76:79], v[156:159], a[76:79], v[76:79]
    ds_read_b128 v[144:147], v212 offset:22528
    v_mfma_f32_16x16x32_bf16 v[72:75], v[156:159], a[72:75], v[72:75]
    s_waitcnt vmcnt(10) lgkmcnt(3)
    v_mfma_f32_16x16x32_bf16 v[48:51], v[128:131], a[80:83], v[48:51]
    ds_read_b128 v[148:151], v212 offset:55296
    buffer_load_dwordx4 a[120:123], v212, s[32:35], s75 offen offset:2048 sc1
    s_waitcnt vmcnt(10)
    v_mfma_f32_16x16x32_bf16 v[52:55], v[128:131], a[84:87], v[52:55]
    v_add_f32 v184, v188, v189
    v_mfma_f32_16x16x32_bf16 v[64:67], v[132:135], a[80:83], v[64:67]
    ds_read_b128 v[152:155], v212 offset:22784
    v_add_f32 v185, v190, v191
    v_mfma_f32_16x16x32_bf16 v[68:71], v[132:135], a[84:87], v[68:71]
    v_add_f32 v184, v184, v185
    s_waitcnt lgkmcnt(3)
    v_mfma_f32_16x16x32_bf16 v[60:63], v[136:139], a[84:87], v[60:63]
    ds_read_b128 v[156:159], v212 offset:55552
    buffer_load_dwordx4 a[124:127], v212, s[32:35], s75 offen offset:2304 sc1
    v_mfma_f32_16x16x32_bf16 v[56:59], v[136:139], a[80:83], v[56:59]
    v_mov_b32 v185, v184
    v_mfma_f32_16x16x32_bf16 v[76:79], v[140:143], a[84:87], v[76:79]
    ds_read_b128 v[128:131], v212 offset:24576
    v_mfma_f32_16x16x32_bf16 v[72:75], v[140:143], a[80:83], v[72:75]
    s_waitcnt vmcnt(10)
    v_cmp_gt_u32 vcc, 16, v5
    s_nop 0
    s_and_b64 vcc, vcc, 0xffff
    s_cbranch_scc1 L_o_15
L_r_16:
    s_waitcnt vmcnt(9) lgkmcnt(3)
    v_mfma_f32_16x16x32_bf16 v[48:51], v[144:147], a[88:91], v[48:51]
    ds_read_b128 v[132:135], v212 offset:57344
    s_add_u32 m0, s17, 102400
    s_add_u32 s44, s22, 200704
    s_waitcnt vmcnt(8)
    v_mfma_f32_16x16x32_bf16 v[52:55], v[144:147], a[92:95], v[52:55]
    buffer_load_dwordx4 v2, s[32:35], s44 offen offset:0 sc1 lds
    v_permlane32_swap_b32 v184, v185
    v_mfma_f32_16x16x32_bf16 v[64:67], v[148:151], a[88:91], v[64:67]
    ds_read_b128 v[136:139], v212 offset:24832
    v_mul_f32 v184, 0x3b000000, v184
    v_mfma_f32_16x16x32_bf16 v[68:71], v[148:151], a[92:95], v[68:71]
    v_mul_f32 v185, 0x3b000000, v185
    s_waitcnt lgkmcnt(3)
    v_mfma_f32_16x16x32_bf16 v[60:63], v[152:155], a[92:95], v[60:63]
    ds_read_b128 v[140:143], v212 offset:57600
    buffer_load_dwordx4 v2, s[32:35], s44 offen offset:1024 sc1 lds
    v_mfma_f32_16x16x32_bf16 v[56:59], v[152:155], a[88:91], v[56:59]
    v_cvt_pk_bf16_f32 v176, -v184, -v184
    v_mfma_f32_16x16x32_bf16 v[76:79], v[156:159], a[92:95], v[76:79]
    ds_read_b128 v[144:147], v212 offset:26624
    v_mfma_f32_16x16x32_bf16 v[72:75], v[156:159], a[88:91], v[72:75]
    v_fma_f32 v185, -v184, v184, v185
    s_waitcnt vmcnt(9) lgkmcnt(3)
    v_mfma_f32_16x16x32_bf16 v[48:51], v[128:131], a[96:99], v[48:51]
    ds_read_b128 v[148:151], v212 offset:59392
    s_waitcnt vmcnt(8)
    v_mfma_f32_16x16x32_bf16 v[52:55], v[128:131], a[100:103], v[52:55]
    v_max_f32 v185, 0, v185
    v_mfma_f32_16x16x32_bf16 v[64:67], v[132:135], a[96:99], v[64:67]
    ds_read_b128 v[152:155], v212 offset:26880
    buffer_load_dwordx4 v2, s[32:35], s44 offen offset:2048 sc1 lds
    v_mfma_f32_16x16x32_bf16 v[68:71], v[132:135], a[100:103], v[68:71]
    v_add_f32 v181, 0x3727c5ac, v185
    s_waitcnt lgkmcnt(3)
    v_mfma_f32_16x16x32_bf16 v[60:63], v[136:139], a[100:103], v[60:63]
    ds_read_b128 v[156:159], v212 offset:59648
    v_mfma_f32_16x16x32_bf16 v[56:59], v[136:139], a[96:99], v[56:59]
    v_mov_b32 v228, v176
    v_mfma_f32_16x16x32_bf16 v[76:79], v[140:143], a[100:103], v[76:79]
    ds_read_b128 v[128:131], v212 offset:28672
    v_mfma_f32_16x16x32_bf16 v[72:75], v[140:143], a[96:99], v[72:75]
    v_mov_b32 v183, v181
    s_waitcnt vmcnt(8) lgkmcnt(3)
    v_mfma_f32_16x16x32_bf16 v[48:51], v[144:147], a[104:107], v[48:51]
    ds_read_b128 v[132:135], v212 offset:61440
    buffer_load_dwordx4 v2, s[32:35], s44 offen offset:3072 sc1 lds
    s_waitcnt vmcnt(8)
    v_mfma_f32_16x16x32_bf16 v[52:55], v[144:147], a[108:111], v[52:55]
    v_rsq_f32 v180, v181
    v_mfma_f32_16x16x32_bf16 v[64:67], v[148:151], a[104:107], v[64:67]
    ds_read_b128 v[136:139], v212 offset:28928
    v_mul_f32 v180, 0xbfb8aa3b, v180
    v_mfma_f32_16x16x32_bf16 v[68:71], v[148:151], a[108:111], v[68:71]
    v_mov_b32 v182, v180
    s_waitcnt lgkmcnt(3)
    v_mfma_f32_16x16x32_bf16 v[60:63], v[152:155], a[108:111], v[60:63]
    ds_read_b128 v[140:143], v212 offset:61696
    v_mfma_f32_16x16x32_bf16 v[56:59], v[152:155], a[104:107], v[56:59]
    v_permlane16_swap_b32 v176, v228
    v_mfma_f32_16x16x32_bf16 v[76:79], v[156:159], a[108:111], v[76:79]
    ds_read_b128 v[144:147], v212 offset:30720
    s_add_u32 m0, s17, 131072
    s_add_u32 s44, s16, 262144
    v_mfma_f32_16x16x32_bf16 v[72:75], v[156:159], a[104:107], v[72:75]
    buffer_load_dwordx4 v2, s[32:35], s44 offen offset:0 sc1 lds
    s_waitcnt vmcnt(8) lgkmcnt(3)
    v_mfma_f32_16x16x32_bf16 v[48:51], v[128:131], a[112:115], v[48:51]
    ds_read_b128 v[148:151], v212 offset:63488
    s_waitcnt vmcnt(7)
    v_mfma_f32_16x16x32_bf16 v[52:55], v[128:131], a[116:119], v[52:55]
    v_permlane16_swap_b32 v181, v183
    v_mfma_f32_16x16x32_bf16 v[64:67], v[132:135], a[112:115], v[64:67]
    ds_read_b128 v[152:155], v212 offset:30976
    buffer_load_dwordx4 v2, s[32:35], s44 offen offset:1024 sc1 lds
    v_mfma_f32_16x16x32_bf16 v[68:71], v[132:135], a[116:119], v[68:71]
    v_permlane16_swap_b32 v180, v182
    s_waitcnt lgkmcnt(3)
    v_mfma_f32_16x16x32_bf16 v[60:63], v[136:139], a[116:119], v[60:63]
    ds_read_b128 v[156:159], v212 offset:63744
    v_mfma_f32_16x16x32_bf16 v[56:59], v[136:139], a[112:115], v[56:59]
    v_cndmask_b32 v176, 0, v176, s[8:9]
    v_mfma_f32_16x16x32_bf16 v[76:79], v[140:143], a[116:119], v[76:79]
    s_barrier
    v_mfma_f32_16x16x32_bf16 v[72:75], v[140:143], a[112:115], v[72:75]
    ds_read_b128 v[128:131], v8 offset:0
    s_waitcnt vmcnt(7) lgkmcnt(3)
    v_mfma_f32_16x16x32_bf16 v[48:51], v[144:147], a[120:123], v[48:51]
    ds_read_b128 v[132:135], v8 offset:256
    buffer_load_dwordx4 v2, s[32:35], s44 offen offset:2048 sc1 lds
    s_waitcnt vmcnt(7)
    v_mfma_f32_16x16x32_bf16 v[52:55], v[144:147], a[124:127], v[52:55]
    v_cndmask_b32 v228, 0, v228, s[8:9]
    v_mfma_f32_16x16x32_bf16 v[64:67], v[148:151], a[120:123], v[64:67]
    ds_read_b128 v[136:139], v8 offset:2048
    v_mfma_f32_16x16x32_bf16 v[68:71], v[148:151], a[124:127], v[68:71]
    s_waitcnt lgkmcnt(3)
    v_mfma_f32_16x16x32_bf16 v[60:63], v[152:155], a[124:127], v[60:63]
    ds_read_b128 v[140:143], v8 offset:2304
    v_mfma_f32_16x16x32_bf16 v[56:59], v[152:155], a[120:123], v[56:59]
    v_mfma_f32_16x16x32_bf16 v[76:79], v[156:159], a[124:127], v[76:79]
    ds_read_b128 v[144:147], v8 offset:4096
    buffer_load_dwordx4 v2, s[32:35], s44 offen offset:3072 sc1 lds
    v_mfma_f32_16x16x32_bf16 v[72:75], v[156:159], a[120:123], v[72:75]
    v_mfma_f32_16x16x32_bf16 v[48:51], v[168:171], v[176:179], v[48:51]
    v_mfma_f32_16x16x32_bf16 v[52:55], v[168:171], v[228:231], v[52:55]
    v_mfma_f32_16x16x32_bf16 v[60:63], v[220:223], v[228:231], v[60:63]
    v_mfma_f32_16x16x32_bf16 v[56:59], v[220:223], v[176:179], v[56:59]
    v_mfma_f32_16x16x32_bf16 v[64:67], v[172:175], v[176:179], v[64:67]
    v_mfma_f32_16x16x32_bf16 v[68:71], v[172:175], v[228:231], v[68:71]
    v_mfma_f32_16x16x32_bf16 v[76:79], v[224:227], v[228:231], v[76:79]
    v_mfma_f32_16x16x32_bf16 v[72:75], v[224:227], v[176:179], v[72:75]
    s_waitcnt lgkmcnt(3)
    v_mfma_f32_16x16x32_bf16 v[80:83], v[128:131], a[0:3], 0
    ds_read_b128 v[148:151], v8 offset:4352
    s_add_u32 m0, s17, 135168
    v_mfma_f32_16x16x32_bf16 v[84:87], v[128:131], a[4:7], 0
    s_add_u32 s44, s16, 266240
    buffer_load_dwordx4 v2, s[32:35], s44 offen offset:0 sc1 lds
    v_mfma_f32_16x16x32_bf16 v[92:95], v[132:135], a[4:7], 0
    ds_read_b128 v[152:155], v8 offset:6144
    buffer_load_dwordx4 v2, s[32:35], s44 offen offset:1024 sc1 lds
    v_mfma_f32_16x16x32_bf16 v[88:91], v[132:135], a[0:3], 0
    v_mul_f32 v184, v48, v180
    s_waitcnt lgkmcnt(3)
    v_mfma_f32_16x16x32_bf16 v[80:83], v[136:139], a[8:11], v[80:83]
    ds_read_b128 v[156:159], v8 offset:6400
    v_mfma_f32_16x16x32_bf16 v[84:87], v[136:139], a[12:15], v[84:87]
    v_mul_f32 v185, v49, v180
    v_mul_f32 v186, v50, v180
    v_mfma_f32_16x16x32_bf16 v[92:95], v[140:143], a[12:15], v[92:95]
    ds_read_b128 v[128:131], v8 offset:8192
    buffer_load_dwordx4 v2, s[32:35], s44 offen offset:2048 sc1 lds
    v_mul_f32 v187, v51, v180
    v_mfma_f32_16x16x32_bf16 v[88:91], v[140:143], a[8:11], v[88:91]
    v_mul_f32 v188, v52, v182
    v_mul_f32 v189, v53, v182
    s_waitcnt lgkmcnt(3)
    v_mfma_f32_16x16x32_bf16 v[80:83], v[144:147], a[16:19], v[80:83]
    ds_read_b128 v[132:135], v8 offset:8448
    v_mul_f32 v190, v54, v182
    v_mfma_f32_16x16x32_bf16 v[84:87], v[144:147], a[20:23], v[84:87]
    v_mul_f32 v191, v55, v182
    v_mfma_f32_16x16x32_bf16 v[92:95], v[148:151], a[20:23], v[92:95]
    ds_read_b128 v[136:139], v8 offset:10240
    buffer_load_dwordx4 v2, s[32:35], s44 offen offset:3072 sc1 lds
    v_exp_f32 v184, v184
    v_mfma_f32_16x16x32_bf16 v[88:91], v[148:151], a[16:19], v[88:91]
    v_mul_f32 v48, v48, v56
    v_exp_f32 v185, v185
    s_waitcnt lgkmcnt(3)
    v_mfma_f32_16x16x32_bf16 v[80:83], v[152:155], a[24:27], v[80:83]
    ds_read_b128 v[140:143], v8 offset:10496
    v_mul_f32 v49, v49, v57
    v_mfma_f32_16x16x32_bf16 v[84:87], v[152:155], a[28:31], v[84:87]
    v_exp_f32 v186, v186
    v_mul_f32 v50, v50, v58
    v_mfma_f32_16x16x32_bf16 v[92:95], v[156:159], a[28:31], v[92:95]
    ds_read_b128 v[144:147], v8 offset:12288
    s_add_u32 s57, s80, 0
    buffer_load_dwordx4 a[128:131], v6, s[32:35], s57 offen sc1
    v_mfma_f32_16x16x32_bf16 v[88:91], v[156:159], a[24:27], v[88:91]
    v_exp_f32 v187, v187
    v_mul_f32 v51, v51, v59
    s_waitcnt lgkmcnt(3)
    v_mfma_f32_16x16x32_bf16 v[80:83], v[128:131], a[32:35], v[80:83]
    ds_read_b128 v[148:151], v8 offset:12544
    buffer_load_dwordx4 a[132:135], v6, s[32:35], s57 offen offset:256 sc1
    v_exp_f32 v188, v188
    v_mfma_f32_16x16x32_bf16 v[84:87], v[128:131], a[36:39], v[84:87]
    v_mul_f32 v52, v52, v60
    v_exp_f32 v189, v189
    v_mfma_f32_16x16x32_bf16 v[92:95], v[132:135], a[36:39], v[92:95]
    ds_read_b128 v[152:155], v8 offset:14336
    v_mul_f32 v53, v53, v61
    v_mfma_f32_16x16x32_bf16 v[88:91], v[132:135], a[32:35], v[88:91]
    v_exp_f32 v190, v190
    s_waitcnt lgkmcnt(3)
    v_mfma_f32_16x16x32_bf16 v[80:83], v[136:139], a[40:43], v[80:83]
    ds_read_b128 v[156:159], v8 offset:14592
    buffer_load_dwordx4 a[136:139], v7, s[32:35], s57 offen sc1
    v_mul_f32 v54, v54, v62
    v_mfma_f32_16x16x32_bf16 v[84:87], v[136:139], a[44:47], v[84:87]
    v_exp_f32 v191, v191
    v_mul_f32 v55, v55, v63
    v_mfma_f32_16x16x32_bf16 v[92:95], v[140:143], a[44:47], v[92:95]
    ds_read_b128 v[128:131], v8 offset:16384
    v_fma_f32 v184, v184, v181, v181
    v_mfma_f32_16x16x32_bf16 v[88:91], v[140:143], a[40:43], v[88:91]
    v_fma_f32 v185, v185, v181, v181
    v_fma_f32 v186, v186, v181, v181
    s_waitcnt lgkmcnt(3)
    v_mfma_f32_16x16x32_bf16 v[80:83], v[144:147], a[48:51], v[80:83]
    ds_read_b128 v[132:135], v8 offset:16640
    buffer_load_dwordx4 a[140:143], v7, s[32:35], s57 offen offset:256 sc1
    v_mfma_f32_16x16x32_bf16 v[84:87], v[144:147], a[52:55], v[84:87]
    v_rcp_f32 v184, v184
    v_fma_f32 v187, v187, v181, v181
    v_mfma_f32_16x16x32_bf16 v[92:95], v[148:151], a[52:55], v[92:95]
    ds_read_b128 v[136:139], v8 offset:18432
    v_rcp_f32 v185, v185
    v_mfma_f32_16x16x32_bf16 v[88:91], v[148:151], a[48:51], v[88:91]
    v_fma_f32 v188, v188, v183, v183
    v_rcp_f32 v186, v186
    s_waitcnt lgkmcnt(3)
    v_mfma_f32_16x16x32_bf16 v[80:83], v[152:155], a[56:59], v[80:83]
    ds_read_b128 v[140:143], v8 offset:18688
    s_add_u32 s57, s80, 2048
    buffer_load_dwordx4 a[144:147], v6, s[32:35], s57 offen sc1
    v_mfma_f32_16x16x32_bf16 v[84:87], v[152:155], a[60:63], v[84:87]
    v_fma_f32 v189, v189, v183, v183
    v_rcp_f32 v187, v187
    v_mfma_f32_16x16x32_bf16 v[92:95], v[156:159], a[60:63], v[92:95]
    ds_read_b128 v[144:147], v8 offset:20480
    v_fma_f32 v190, v190, v183, v183
    v_mfma_f32_16x16x32_bf16 v[88:91], v[156:159], a[56:59], v[88:91]
    v_rcp_f32 v188, v188
    v_fma_f32 v191, v191, v183, v183
    s_waitcnt lgkmcnt(3)
    v_mfma_f32_16x16x32_bf16 v[80:83], v[128:131], a[64:67], v[80:83]
    ds_read_b128 v[148:151], v8 offset:20736
    buffer_load_dwordx4 a[148:151], v6, s[32:35], s57 offen offset:256 sc1
    v_mov_b32 v168, v162
    v_mfma_f32_16x16x32_bf16 v[84:87], v[128:131], a[68:71], v[84:87]
    v_rcp_f32 v189, v189
    v_mul_f32 v48, v48, v184
    v_rcp_f32 v190, v190
    v_mfma_f32_16x16x32_bf16 v[92:95], v[132:135], a[68:71], v[92:95]
    ds_read_b128 v[152:155], v8 offset:22528
    buffer_load_dwordx4 a[152:155], v7, s[32:35], s57 offen sc1
    v_mov_b32 v220, v215
    v_mfma_f32_16x16x32_bf16 v[88:91], v[132:135], a[64:67], v[88:91]
    v_mul_f32 v49, v49, v185
    v_rcp_f32 v191, v191
    s_waitcnt lgkmcnt(3)
    v_mfma_f32_16x16x32_bf16 v[80:83], v[136:139], a[72:75], v[80:83]
    ds_read_b128 v[156:159], v8 offset:22784
    v_mul_f32 v50, v50, v186
    v_mfma_f32_16x16x32_bf16 v[84:87], v[136:139], a[76:79], v[84:87]
    v_mul_f32 v51, v51, v187
    v_mul_f32 v52, v52, v188
    v_mfma_f32_16x16x32_bf16 v[92:95], v[140:143], a[76:79], v[92:95]
    ds_read_b128 v[128:131], v8 offset:24576
    buffer_load_dwordx4 a[156:159], v7, s[32:35], s57 offen offset:256 sc1
    v_mul_f32 v53, v53, v189
    v_mfma_f32_16x16x32_bf16 v[88:91], v[140:143], a[72:75], v[88:91]
    v_mul_f32 v54, v54, v190
    v_mul_f32 v55, v55, v191
    s_waitcnt lgkmcnt(3)
    v_mfma_f32_16x16x32_bf16 v[80:83], v[144:147], a[80:83], v[80:83]
    ds_read_b128 v[132:135], v8 offset:24832
    v_cvt_pk_bf16_f32 v192, v48, v49
    v_mfma_f32_16x16x32_bf16 v[84:87], v[144:147], a[84:87], v[84:87]
    v_cvt_pk_bf16_f32 v194, v52, v53
    v_mfma_f32_16x16x32_bf16 v[92:95], v[148:151], a[84:87], v[92:95]
    ds_read_b128 v[136:139], v8 offset:26624
    s_add_u32 s57, s80, 4096
    buffer_load_dwordx4 a[160:163], v6, s[32:35], s57 offen sc1
    v_mfma_f32_16x16x32_bf16 v[88:91], v[148:151], a[80:83], v[88:91]
    v_cvt_pk_bf16_f32 v193, v50, v51
    v_cvt_pk_bf16_f32 v195, v54, v55
    v_permlane16_swap_b32 v192, v194
    s_waitcnt lgkmcnt(3)
    v_mfma_f32_16x16x32_bf16 v[80:83], v[152:155], a[88:91], v[80:83]
    ds_read_b128 v[140:143], v8 offset:26880
    v_permlane16_swap_b32 v193, v195
    v_mfma_f32_16x16x32_bf16 v[84:87], v[152:155], a[92:95], v[84:87]
    buffer_store_dwordx4 v[192:195], v2, s[32:35], s77 offen offset:0 sc1
    v_mfma_f32_16x16x32_bf16 v[92:95], v[156:159], a[92:95], v[92:95]
    ds_read_b128 v[144:147], v8 offset:28672
    buffer_load_dwordx4 a[164:167], v6, s[32:35], s57 offen offset:256 sc1
    v_mul_f32 v196, v64, v180
    v_mfma_f32_16x16x32_bf16 v[88:91], v[156:159], a[88:91], v[88:91]
    v_mul_f32 v197, v65, v180
    v_mul_f32 v198, v66, v180
    s_waitcnt lgkmcnt(3)
    v_mfma_f32_16x16x32_bf16 v[80:83], v[128:131], a[96:99], v[80:83]
    ds_read_b128 v[148:151], v8 offset:28928
    buffer_load_dwordx4 a[168:171], v7, s[32:35], s57 offen sc1
    v_mul_f32 v199, v67, v180
    v_mfma_f32_16x16x32_bf16 v[84:87], v[128:131], a[100:103], v[84:87]
    v_mul_f32 v200, v68, v182
    v_mul_f32 v201, v69, v182
    v_mfma_f32_16x16x32_bf16 v[92:95], v[132:135], a[100:103], v[92:95]
    ds_read_b128 v[152:155], v8 offset:30720
    v_mul_f32 v202, v70, v182
    v_mfma_f32_16x16x32_bf16 v[88:91], v[132:135], a[96:99], v[88:91]
    v_mul_f32 v203, v71, v182
    s_waitcnt lgkmcnt(3)
    v_mfma_f32_16x16x32_bf16 v[80:83], v[136:139], a[104:107], v[80:83]
    ds_read_b128 v[156:159], v8 offset:30976
    buffer_load_dwordx4 a[172:175], v7, s[32:35], s57 offen offset:256 sc1
    v_exp_f32 v196, v196
    v_mfma_f32_16x16x32_bf16 v[84:87], v[136:139], a[108:111], v[84:87]
    v_mul_f32 v64, v64, v72
    v_exp_f32 v197, v197
    v_mfma_f32_16x16x32_bf16 v[92:95], v[140:143], a[108:111], v[92:95]
    s_waitcnt vmcnt(21)
    s_barrier
    ds_read_b128 v[128:131], v8 offset:32768
    v_mfma_f32_16x16x32_bf16 v[88:91], v[140:143], a[104:107], v[88:91]
    v_mul_f32 v65, v65, v73
    v_exp_f32 v198, v198
    s_waitcnt lgkmcnt(3)
    v_mfma_f32_16x16x32_bf16 v[80:83], v[144:147], a[112:115], v[80:83]
    ds_read_b128 v[132:135], v8 offset:33024
    s_add_u32 s57, s80, 65536
    buffer_load_dwordx4 a[176:179], v6, s[32:35], s57 offen sc1
    v_mul_f32 v66, v66, v74
    v_mfma_f32_16x16x32_bf16 v[84:87], v[144:147], a[116:119], v[84:87]
    v_exp_f32 v199, v199
    v_mul_f32 v67, v67, v75
    v_mfma_f32_16x16x32_bf16 v[92:95], v[148:151], a[116:119], v[92:95]
    ds_read_b128 v[136:139], v8 offset:34816
    v_exp_f32 v200, v200
    v_mfma_f32_16x16x32_bf16 v[88:91], v[148:151], a[112:115], v[88:91]
    v_mul_f32 v68, v68, v76
    v_exp_f32 v201, v201
    s_waitcnt lgkmcnt(3)
    v_mfma_f32_16x16x32_bf16 v[80:83], v[152:155], a[120:123], v[80:83]
    ds_read_b128 v[140:143], v8 offset:35072
    buffer_load_dwordx4 a[180:183], v6, s[32:35], s57 offen offset:256 sc1
    v_mul_f32 v69, v69, v77
    v_mfma_f32_16x16x32_bf16 v[84:87], v[152:155], a[124:127], v[84:87]
    v_exp_f32 v202, v202
    v_mfma_f32_16x16x32_bf16 v[92:95], v[156:159], a[124:127], v[92:95]
    ds_read_b128 v[144:147], v8 offset:36864
    v_mul_f32 v70, v70, v78
    v_mfma_f32_16x16x32_bf16 v[88:91], v[156:159], a[120:123], v[88:91]
    v_exp_f32 v203, v203
    v_mul_f32 v71, v71, v79
    v_mfma_f32_16x16x32_bf16 v[80:83], v[168:171], v[176:179], v[80:83]
    v_fma_f32 v196, v196, v181, v181
    v_mfma_f32_16x16x32_bf16 v[84:87], v[168:171], v[228:231], v[84:87]
    v_fma_f32 v197, v197, v181, v181
    v_mfma_f32_16x16x32_bf16 v[92:95], v[220:223], v[228:231], v[92:95]
    v_fma_f32 v198, v198, v181, v181
    v_mfma_f32_16x16x32_bf16 v[88:91], v[220:223], v[176:179], v[88:91]
    v_fma_f32 v199, v199, v181, v181
    s_waitcnt lgkmcnt(3)
    v_mfma_f32_16x16x32_bf16 v[96:99], v[128:131], a[0:3], 0
    ds_read_b128 v[148:151], v8 offset:37120
    s_add_u32 m0, s17, 0
    s_add_u32 s44, s16, 327680
    buffer_load_dwordx4 v2, s[32:35], s44 offen offset:0 sc1 lds
    v_mfma_f32_16x16x32_bf16 v[100:103], v[128:131], a[4:7], 0
    v_rcp_f32 v196, v196
    v_mfma_f32_16x16x32_bf16 v[108:111], v[132:135], a[4:7], 0
    ds_read_b128 v[152:155], v8 offset:38912
    buffer_load_dwordx4 v2, s[32:35], s44 offen offset:1024 sc1 lds
    v_rcp_f32 v197, v197
    v_mfma_f32_16x16x32_bf16 v[104:107], v[132:135], a[0:3], 0
    v_fma_f32 v200, v200, v183, v183
    v_rcp_f32 v198, v198
    s_waitcnt lgkmcnt(3)
    v_mfma_f32_16x16x32_bf16 v[96:99], v[136:139], a[8:11], v[96:99]
    ds_read_b128 v[156:159], v8 offset:39168
    v_fma_f32 v201, v201, v183, v183
    v_mfma_f32_16x16x32_bf16 v[100:103], v[136:139], a[12:15], v[100:103]
    v_rcp_f32 v199, v199
    v_mfma_f32_16x16x32_bf16 v[108:111], v[140:143], a[12:15], v[108:111]
    ds_read_b128 v[128:131], v8 offset:40960
    buffer_load_dwordx4 v2, s[32:35], s44 offen offset:2048 sc1 lds
    v_fma_f32 v202, v202, v183, v183
    v_mfma_f32_16x16x32_bf16 v[104:107], v[140:143], a[8:11], v[104:107]
    v_rcp_f32 v200, v200
    v_fma_f32 v203, v203, v183, v183
    s_waitcnt lgkmcnt(3)
    v_mfma_f32_16x16x32_bf16 v[96:99], v[144:147], a[16:19], v[96:99]
    ds_read_b128 v[132:135], v8 offset:41216
    v_mfma_f32_16x16x32_bf16 v[100:103], v[144:147], a[20:23], v[100:103]
    v_rcp_f32 v201, v201
    v_mul_f32 v64, v64, v196
    v_mfma_f32_16x16x32_bf16 v[108:111], v[148:151], a[20:23], v[108:111]
    ds_read_b128 v[136:139], v8 offset:43008
    buffer_load_dwordx4 v2, s[32:35], s44 offen offset:3072 sc1 lds
    v_rcp_f32 v202, v202
    v_mfma_f32_16x16x32_bf16 v[104:107], v[148:151], a[16:19], v[104:107]
    v_mul_f32 v65, v65, v197
    v_rcp_f32 v203, v203
    s_waitcnt lgkmcnt(3)
    v_mfma_f32_16x16x32_bf16 v[96:99], v[152:155], a[24:27], v[96:99]
    ds_read_b128 v[140:143], v8 offset:43264
    v_mul_f32 v66, v66, v198
    v_mfma_f32_16x16x32_bf16 v[100:103], v[152:155], a[28:31], v[100:103]
    v_mul_f32 v67, v67, v199
    v_mfma_f32_16x16x32_bf16 v[108:111], v[156:159], a[28:31], v[108:111]
    ds_read_b128 v[144:147], v8 offset:45056
    s_add_u32 m0, s17, 4096
    s_add_u32 s44, s16, 331776
    buffer_load_dwordx4 v2, s[32:35], s44 offen offset:0 sc1 lds
    v_mfma_f32_16x16x32_bf16 v[104:107], v[156:159], a[24:27], v[104:107]
    v_mul_f32 v68, v68, v200
    v_mul_f32 v69, v69, v201
    v_mul_f32 v70, v70, v202
    s_waitcnt lgkmcnt(3)
    v_mfma_f32_16x16x32_bf16 v[96:99], v[128:131], a[32:35], v[96:99]
    ds_read_b128 v[148:151], v8 offset:45312
    buffer_load_dwordx4 v2, s[32:35], s44 offen offset:1024 sc1 lds
    v_mfma_f32_16x16x32_bf16 v[100:103], v[128:131], a[36:39], v[100:103]
    v_mul_f32 v71, v71, v203
    v_cvt_pk_bf16_f32 v204, v64, v65
    v_mfma_f32_16x16x32_bf16 v[108:111], v[132:135], a[36:39], v[108:111]
    ds_read_b128 v[152:155], v8 offset:47104
    v_cvt_pk_bf16_f32 v206, v68, v69
    v_mfma_f32_16x16x32_bf16 v[104:107], v[132:135], a[32:35], v[104:107]
    v_cvt_pk_bf16_f32 v205, v66, v67
    v_cvt_pk_bf16_f32 v207, v70, v71
    s_waitcnt lgkmcnt(3)
    v_mfma_f32_16x16x32_bf16 v[96:99], v[136:139], a[40:43], v[96:99]
    ds_read_b128 v[156:159], v8 offset:47360
    buffer_load_dwordx4 v2, s[32:35], s44 offen offset:2048 sc1 lds
    v_mfma_f32_16x16x32_bf16 v[100:103], v[136:139], a[44:47], v[100:103]
    v_permlane16_swap_b32 v204, v206
    v_permlane16_swap_b32 v205, v207
    v_mfma_f32_16x16x32_bf16 v[108:111], v[140:143], a[44:47], v[108:111]
    ds_read_b128 v[128:131], v8 offset:49152
    buffer_store_dwordx4 v[204:207], v2, s[32:35], s77 offen offset:1024 sc1
    v_mfma_f32_16x16x32_bf16 v[104:107], v[140:143], a[40:43], v[104:107]
    v_mul_f32 v184, v80, v180
    v_mul_f32 v185, v81, v180
    s_waitcnt lgkmcnt(3)
    v_mfma_f32_16x16x32_bf16 v[96:99], v[144:147], a[48:51], v[96:99]
    ds_read_b128 v[132:135], v8 offset:49408
    buffer_load_dwordx4 v2, s[32:35], s44 offen offset:3072 sc1 lds
    v_mul_f32 v186, v82, v180
    v_mfma_f32_16x16x32_bf16 v[100:103], v[144:147], a[52:55], v[100:103]
    v_mul_f32 v187, v83, v180
    v_mul_f32 v188, v84, v182
    v_mfma_f32_16x16x32_bf16 v[108:111], v[148:151], a[52:55], v[108:111]
    ds_read_b128 v[136:139], v8 offset:51200
    v_mul_f32 v189, v85, v182
    v_mfma_f32_16x16x32_bf16 v[104:107], v[148:151], a[48:51], v[104:107]
    v_mul_f32 v190, v86, v182
    s_waitcnt lgkmcnt(3)
    v_mfma_f32_16x16x32_bf16 v[96:99], v[152:155], a[56:59], v[96:99]
    ds_read_b128 v[140:143], v8 offset:51456
    buffer_load_dwordx4 a[184:187], v7, s[32:35], s57 offen sc1
    v_mul_f32 v191, v87, v182
    v_mfma_f32_16x16x32_bf16 v[100:103], v[152:155], a[60:63], v[100:103]
    v_exp_f32 v184, v184
    v_mul_f32 v80, v80, v88
    v_mfma_f32_16x16x32_bf16 v[108:111], v[156:159], a[60:63], v[108:111]
    ds_read_b128 v[144:147], v8 offset:53248
    v_mfma_f32_16x16x32_bf16 v[104:107], v[156:159], a[56:59], v[104:107]
    v_exp_f32 v185, v185
    v_mul_f32 v81, v81, v89
    s_waitcnt lgkmcnt(3)
    v_mfma_f32_16x16x32_bf16 v[96:99], v[128:131], a[64:67], v[96:99]
    ds_read_b128 v[148:151], v8 offset:53504
    buffer_load_dwordx4 a[188:191], v7, s[32:35], s57 offen offset:256 sc1
    v_mov_b32 v172, v163
    v_mfma_f32_16x16x32_bf16 v[100:103], v[128:131], a[68:71], v[100:103]
    v_exp_f32 v186, v186
    v_mul_f32 v82, v82, v90
    v_exp_f32 v187, v187
    v_mfma_f32_16x16x32_bf16 v[108:111], v[132:135], a[68:71], v[108:111]
    ds_read_b128 v[152:155], v8 offset:55296
    s_add_u32 s57, s80, 67584
    buffer_load_dwordx4 a[192:195], v6, s[32:35], s57 offen sc1
    v_mov_b32 v224, v216
    v_mfma_f32_16x16x32_bf16 v[104:107], v[132:135], a[64:67], v[104:107]
    v_mul_f32 v83, v83, v91
    v_exp_f32 v188, v188
    s_waitcnt lgkmcnt(3)
    v_mfma_f32_16x16x32_bf16 v[96:99], v[136:139], a[72:75], v[96:99]
    ds_read_b128 v[156:159], v8 offset:55552
    v_mul_f32 v84, v84, v92
    v_mfma_f32_16x16x32_bf16 v[100:103], v[136:139], a[76:79], v[100:103]
    v_exp_f32 v189, v189
    v_mul_f32 v85, v85, v93
    v_mfma_f32_16x16x32_bf16 v[108:111], v[140:143], a[76:79], v[108:111]
    ds_read_b128 v[128:131], v8 offset:57344
    buffer_load_dwordx4 a[196:199], v6, s[32:35], s57 offen offset:256 sc1
    v_mfma_f32_16x16x32_bf16 v[104:107], v[140:143], a[72:75], v[104:107]
    v_exp_f32 v190, v190
    v_mul_f32 v86, v86, v94
    s_waitcnt lgkmcnt(3)
    v_mfma_f32_16x16x32_bf16 v[96:99], v[144:147], a[80:83], v[96:99]
    ds_read_b128 v[132:135], v8 offset:57600
    v_exp_f32 v191, v191
    v_mfma_f32_16x16x32_bf16 v[100:103], v[144:147], a[84:87], v[100:103]
    v_mul_f32 v87, v87, v95
    v_fma_f32 v184, v184, v181, v181
    v_mfma_f32_16x16x32_bf16 v[108:111], v[148:151], a[84:87], v[108:111]
    ds_read_b128 v[136:139], v8 offset:59392
    buffer_load_dwordx4 a[200:203], v7, s[32:35], s57 offen sc1
    v_mfma_f32_16x16x32_bf16 v[104:107], v[148:151], a[80:83], v[104:107]
    v_fma_f32 v185, v185, v181, v181
    v_fma_f32 v186, v186, v181, v181
    s_waitcnt lgkmcnt(3)
    v_mfma_f32_16x16x32_bf16 v[96:99], v[152:155], a[88:91], v[96:99]
    ds_read_b128 v[140:143], v8 offset:59648
    v_rcp_f32 v184, v184
    v_mfma_f32_16x16x32_bf16 v[100:103], v[152:155], a[92:95], v[100:103]
    v_fma_f32 v187, v187, v181, v181
    v_rcp_f32 v185, v185
    v_mfma_f32_16x16x32_bf16 v[108:111], v[156:159], a[92:95], v[108:111]
    ds_read_b128 v[144:147], v8 offset:61440
    buffer_load_dwordx4 a[204:207], v7, s[32:35], s57 offen offset:256 sc1
    v_fma_f32 v188, v188, v183, v183
    v_mfma_f32_16x16x32_bf16 v[104:107], v[156:159], a[88:91], v[104:107]
    v_rcp_f32 v186, v186
    v_fma_f32 v189, v189, v183, v183
    s_waitcnt lgkmcnt(3)
    v_mfma_f32_16x16x32_bf16 v[96:99], v[128:131], a[96:99], v[96:99]
    ds_read_b128 v[148:151], v8 offset:61696
    s_add_u32 s57, s80, 69632
    buffer_load_dwordx4 a[208:211], v6, s[32:35], s57 offen sc1
    v_mfma_f32_16x16x32_bf16 v[100:103], v[128:131], a[100:103], v[100:103]
    v_rcp_f32 v187, v187
    v_fma_f32 v190, v190, v183, v183
    v_mfma_f32_16x16x32_bf16 v[108:111], v[132:135], a[100:103], v[108:111]
    ds_read_b128 v[152:155], v8 offset:63488
    v_rcp_f32 v188, v188
    v_mfma_f32_16x16x32_bf16 v[104:107], v[132:135], a[96:99], v[104:107]
    v_fma_f32 v191, v191, v183, v183
    v_rcp_f32 v189, v189
    s_waitcnt lgkmcnt(3)
    v_mfma_f32_16x16x32_bf16 v[96:99], v[136:139], a[104:107], v[96:99]
    ds_read_b128 v[156:159], v8 offset:63744
    buffer_load_dwordx4 a[212:215], v6, s[32:35], s57 offen offset:256 sc1
    v_mul_f32 v80, v80, v184
    v_mfma_f32_16x16x32_bf16 v[100:103], v[136:139], a[108:111], v[100:103]
    v_rcp_f32 v190, v190
    v_mfma_f32_16x16x32_bf16 v[108:111], v[140:143], a[108:111], v[108:111]
    s_waitcnt vmcnt(32)
    s_barrier
    ds_read_b128 v[128:131], v9 offset:0
    v_mul_f32 v81, v81, v185
    v_mfma_f32_16x16x32_bf16 v[104:107], v[140:143], a[104:107], v[104:107]
    v_rcp_f32 v191, v191
    v_mul_f32 v82, v82, v186
    s_waitcnt lgkmcnt(3)
    v_mfma_f32_16x16x32_bf16 v[96:99], v[144:147], a[112:115], v[96:99]
    ds_read_b128 v[132:135], v9 offset:256
    buffer_load_dwordx4 a[216:219], v7, s[32:35], s57 offen sc1
    v_mfma_f32_16x16x32_bf16 v[100:103], v[144:147], a[116:119], v[100:103]
    v_mul_f32 v83, v83, v187
    v_mul_f32 v84, v84, v188
    v_mfma_f32_16x16x32_bf16 v[108:111], v[148:151], a[116:119], v[108:111]
    ds_read_b128 v[136:139], v9 offset:2048
    v_mul_f32 v85, v85, v189
    v_mfma_f32_16x16x32_bf16 v[104:107], v[148:151], a[112:115], v[104:107]
    v_mul_f32 v86, v86, v190
    v_mul_f32 v87, v87, v191
    s_waitcnt lgkmcnt(3)
    v_mfma_f32_16x16x32_bf16 v[96:99], v[152:155], a[120:123], v[96:99]
    ds_read_b128 v[140:143], v9 offset:2304
    buffer_load_dwordx4 a[220:223], v7, s[32:35], s57 offen offset:256 sc1
    v_mfma_f32_16x16x32_bf16 v[100:103], v[152:155], a[124:127], v[100:103]
    v_cvt_pk_bf16_f32 v192, v80, v81
    v_cvt_pk_bf16_f32 v194, v84, v85
    v_mfma_f32_16x16x32_bf16 v[108:111], v[156:159], a[124:127], v[108:111]
    ds_read_b128 v[144:147], v9 offset:4096
    v_cvt_pk_bf16_f32 v193, v82, v83
    v_mfma_f32_16x16x32_bf16 v[104:107], v[156:159], a[120:123], v[104:107]
    v_cvt_pk_bf16_f32 v195, v86, v87
    v_permlane16_swap_b32 v192, v194
    v_mfma_f32_16x16x32_bf16 v[96:99], v[172:175], v[176:179], v[96:99]
    v_permlane16_swap_b32 v193, v195
    v_mfma_f32_16x16x32_bf16 v[100:103], v[172:175], v[228:231], v[100:103]
    v_mfma_f32_16x16x32_bf16 v[108:111], v[224:227], v[228:231], v[108:111]
    v_mfma_f32_16x16x32_bf16 v[104:107], v[224:227], v[176:179], v[104:107]
    buffer_store_dwordx4 v[192:195], v2, s[32:35], s77 offen offset:2048 sc1
    s_waitcnt lgkmcnt(3)
    v_mfma_f32_16x16x32_bf16 v[48:51], v[128:131], a[0:3], 0
    ds_read_b128 v[148:151], v9 offset:4352
    s_add_u32 m0, s17, 32768
    v_mfma_f32_16x16x32_bf16 v[52:55], v[128:131], a[4:7], 0
    s_add_u32 s44, s22, 393216
    buffer_load_dwordx4 v2, s[32:35], s44 offen offset:0 sc1 lds
    v_mfma_f32_16x16x32_bf16 v[60:63], v[132:135], a[4:7], 0
    ds_read_b128 v[152:155], v9 offset:6144
    buffer_load_dwordx4 v2, s[32:35], s44 offen offset:1024 sc1 lds
    v_mfma_f32_16x16x32_bf16 v[56:59], v[132:135], a[0:3], 0
    v_mul_f32 v196, v96, v180
    s_waitcnt lgkmcnt(3)
    v_mfma_f32_16x16x32_bf16 v[48:51], v[136:139], a[8:11], v[48:51]
    ds_read_b128 v[156:159], v9 offset:6400
    v_mul_f32 v197, v97, v180
    v_mfma_f32_16x16x32_bf16 v[52:55], v[136:139], a[12:15], v[52:55]
    v_mul_f32 v198, v98, v180
    v_mul_f32 v199, v99, v180
    v_mfma_f32_16x16x32_bf16 v[60:63], v[140:143], a[12:15], v[60:63]
    ds_read_b128 v[128:131], v9 offset:8192
    buffer_load_dwordx4 v2, s[32:35], s44 offen offset:2048 sc1 lds
    v_mul_f32 v200, v100, v182
    v_mfma_f32_16x16x32_bf16 v[56:59], v[140:143], a[8:11], v[56:59]
    v_mul_f32 v201, v101, v182
    v_mul_f32 v202, v102, v182
    s_waitcnt lgkmcnt(3)
    v_mfma_f32_16x16x32_bf16 v[48:51], v[144:147], a[16:19], v[48:51]
    ds_read_b128 v[132:135], v9 offset:8448
    v_mul_f32 v203, v103, v182
    v_mfma_f32_16x16x32_bf16 v[52:55], v[144:147], a[20:23], v[52:55]
    v_exp_f32 v196, v196
    v_mul_f32 v96, v96, v104
    v_mfma_f32_16x16x32_bf16 v[60:63], v[148:151], a[20:23], v[60:63]
    ds_read_b128 v[136:139], v9 offset:10240
    buffer_load_dwordx4 v2, s[32:35], s44 offen offset:3072 sc1 lds
    v_exp_f32 v197, v197
    v_mfma_f32_16x16x32_bf16 v[56:59], v[148:151], a[16:19], v[56:59]
    v_mul_f32 v97, v97, v105
    v_exp_f32 v198, v198
    s_waitcnt lgkmcnt(3)
    v_mfma_f32_16x16x32_bf16 v[48:51], v[152:155], a[24:27], v[48:51]
    ds_read_b128 v[140:143], v9 offset:10496
    v_mul_f32 v98, v98, v106
    v_mfma_f32_16x16x32_bf16 v[52:55], v[152:155], a[28:31], v[52:55]
    v_exp_f32 v199, v199
    v_mul_f32 v99, v99, v107
    v_mfma_f32_16x16x32_bf16 v[60:63], v[156:159], a[28:31], v[60:63]
    ds_read_b128 v[144:147], v9 offset:12288
    s_add_u32 m0, s17, 36864
    s_add_u32 s44, s22, 397312
    buffer_load_dwordx4 v2, s[32:35], s44 offen offset:0 sc1 lds
    v_mfma_f32_16x16x32_bf16 v[56:59], v[156:159], a[24:27], v[56:59]
    v_exp_f32 v200, v200
    v_mul_f32 v100, v100, v108
    v_exp_f32 v201, v201
    s_waitcnt lgkmcnt(3)
    v_mfma_f32_16x16x32_bf16 v[48:51], v[128:131], a[32:35], v[48:51]
    ds_read_b128 v[148:151], v9 offset:12544
    buffer_load_dwordx4 v2, s[32:35], s44 offen offset:1024 sc1 lds
    v_mul_f32 v101, v101, v109
    v_mfma_f32_16x16x32_bf16 v[52:55], v[128:131], a[36:39], v[52:55]
    v_exp_f32 v202, v202
    v_mul_f32 v102, v102, v110
    v_mfma_f32_16x16x32_bf16 v[60:63], v[132:135], a[36:39], v[60:63]
    ds_read_b128 v[152:155], v9 offset:14336
    v_exp_f32 v203, v203
    v_mfma_f32_16x16x32_bf16 v[56:59], v[132:135], a[32:35], v[56:59]
    v_mul_f32 v103, v103, v111
    v_fma_f32 v196, v196, v181, v181
    s_waitcnt lgkmcnt(3)
    v_mfma_f32_16x16x32_bf16 v[48:51], v[136:139], a[40:43], v[48:51]
    ds_read_b128 v[156:159], v9 offset:14592
    buffer_load_dwordx4 v2, s[32:35], s44 offen offset:2048 sc1 lds
    v_fma_f32 v197, v197, v181, v181
    v_mfma_f32_16x16x32_bf16 v[52:55], v[136:139], a[44:47], v[52:55]
    v_fma_f32 v198, v198, v181, v181
    v_rcp_f32 v196, v196
    v_mfma_f32_16x16x32_bf16 v[60:63], v[140:143], a[44:47], v[60:63]
    ds_read_b128 v[128:131], v9 offset:16384
    v_fma_f32 v199, v199, v181, v181
    v_mfma_f32_16x16x32_bf16 v[56:59], v[140:143], a[40:43], v[56:59]
    v_rcp_f32 v197, v197
    v_fma_f32 v200, v200, v183, v183
    s_waitcnt lgkmcnt(3)
    v_mfma_f32_16x16x32_bf16 v[48:51], v[144:147], a[48:51], v[48:51]
    ds_read_b128 v[132:135], v9 offset:16640
    buffer_load_dwordx4 v2, s[32:35], s44 offen offset:3072 sc1 lds
    v_rcp_f32 v198, v198
    v_mfma_f32_16x16x32_bf16 v[52:55], v[144:147], a[52:55], v[52:55]
    v_fma_f32 v201, v201, v183, v183
    v_rcp_f32 v199, v199
    v_mfma_f32_16x16x32_bf16 v[60:63], v[148:151], a[52:55], v[60:63]
    ds_read_b128 v[136:139], v9 offset:18432
    v_fma_f32 v202, v202, v183, v183
    v_mfma_f32_16x16x32_bf16 v[56:59], v[148:151], a[48:51], v[56:59]
    v_rcp_f32 v200, v200
    v_fma_f32 v203, v203, v183, v183
    s_waitcnt lgkmcnt(3)
    v_mfma_f32_16x16x32_bf16 v[48:51], v[152:155], a[56:59], v[48:51]
    ds_read_b128 v[140:143], v9 offset:18688
    s_add_u32 s57, s80, 6144
    buffer_load_dwordx4 a[224:227], v6, s[32:35], s57 offen sc1
    v_mfma_f32_16x16x32_bf16 v[52:55], v[152:155], a[60:63], v[52:55]
    v_rcp_f32 v201, v201
    v_mul_f32 v96, v96, v196
    v_rcp_f32 v202, v202
    v_mfma_f32_16x16x32_bf16 v[60:63], v[156:159], a[60:63], v[60:63]
    ds_read_b128 v[144:147], v9 offset:20480
    v_mul_f32 v97, v97, v197
    v_mfma_f32_16x16x32_bf16 v[56:59], v[156:159], a[56:59], v[56:59]
    v_rcp_f32 v203, v203
    v_mul_f32 v98, v98, v198
    s_waitcnt lgkmcnt(3)
    v_mfma_f32_16x16x32_bf16 v[48:51], v[128:131], a[64:67], v[48:51]
    ds_read_b128 v[148:151], v9 offset:20736
    buffer_load_dwordx4 a[228:231], v6, s[32:35], s57 offen offset:256 sc1
    v_mov_b32 v168, v164
    v_mfma_f32_16x16x32_bf16 v[52:55], v[128:131], a[68:71], v[52:55]
    v_mul_f32 v99, v99, v199
    v_mul_f32 v100, v100, v200
    v_mul_f32 v101, v101, v201
    v_mfma_f32_16x16x32_bf16 v[60:63], v[132:135], a[68:71], v[60:63]
    ds_read_b128 v[152:155], v9 offset:22528
    buffer_load_dwordx4 a[232:235], v7, s[32:35], s57 offen sc1
    v_mov_b32 v220, v217
    v_mfma_f32_16x16x32_bf16 v[56:59], v[132:135], a[64:67], v[56:59]
    v_mul_f32 v102, v102, v202
    v_mul_f32 v103, v103, v203
    v_cvt_pk_bf16_f32 v204, v96, v97
    s_waitcnt lgkmcnt(3)
    v_mfma_f32_16x16x32_bf16 v[48:51], v[136:139], a[72:75], v[48:51]
    ds_read_b128 v[156:159], v9 offset:22784
    v_cvt_pk_bf16_f32 v206, v100, v101
    v_mfma_f32_16x16x32_bf16 v[52:55], v[136:139], a[76:79], v[52:55]
    v_cvt_pk_bf16_f32 v205, v98, v99
    v_cvt_pk_bf16_f32 v207, v102, v103
    v_mfma_f32_16x16x32_bf16 v[60:63], v[140:143], a[76:79], v[60:63]
    ds_read_b128 v[128:131], v9 offset:24576
    buffer_load_dwordx4 a[236:239], v7, s[32:35], s57 offen offset:256 sc1
    v_permlane16_swap_b32 v204, v206
    v_mfma_f32_16x16x32_bf16 v[56:59], v[140:143], a[72:75], v[56:59]
    v_permlane16_swap_b32 v205, v207
    buffer_store_dwordx4 v[204:207], v2, s[32:35], s77 offen offset:3072 sc1
    s_waitcnt lgkmcnt(3)
    v_mfma_f32_16x16x32_bf16 v[48:51], v[144:147], a[80:83], v[48:51]
    ds_read_b128 v[132:135], v9 offset:24832
    v_mfma_f32_16x16x32_bf16 v[52:55], v[144:147], a[84:87], v[52:55]
    v_mfma_f32_16x16x32_bf16 v[60:63], v[148:151], a[84:87], v[60:63]
    ds_read_b128 v[136:139], v9 offset:26624
    s_add_u32 s57, s80, 71680
    v_mfma_f32_16x16x32_bf16 v[56:59], v[148:151], a[80:83], v[56:59]
    buffer_load_dwordx4 a[240:243], v6, s[32:35], s57 offen sc1
    s_waitcnt lgkmcnt(3)
    v_mfma_f32_16x16x32_bf16 v[48:51], v[152:155], a[88:91], v[48:51]
    ds_read_b128 v[140:143], v9 offset:26880
    v_mfma_f32_16x16x32_bf16 v[52:55], v[152:155], a[92:95], v[52:55]
    v_mfma_f32_16x16x32_bf16 v[60:63], v[156:159], a[92:95], v[60:63]
    ds_read_b128 v[144:147], v9 offset:28672
    buffer_load_dwordx4 a[244:247], v6, s[32:35], s57 offen offset:256 sc1
    v_mfma_f32_16x16x32_bf16 v[56:59], v[156:159], a[88:91], v[56:59]
    s_waitcnt lgkmcnt(3)
    v_mfma_f32_16x16x32_bf16 v[48:51], v[128:131], a[96:99], v[48:51]
    ds_read_b128 v[148:151], v9 offset:28928
    buffer_load_dwordx4 a[248:251], v7, s[32:35], s57 offen sc1
    v_mfma_f32_16x16x32_bf16 v[52:55], v[128:131], a[100:103], v[52:55]
    v_mfma_f32_16x16x32_bf16 v[60:63], v[132:135], a[100:103], v[60:63]
    ds_read_b128 v[152:155], v9 offset:30720
    v_mfma_f32_16x16x32_bf16 v[56:59], v[132:135], a[96:99], v[56:59]
    s_waitcnt lgkmcnt(3)
    v_mfma_f32_16x16x32_bf16 v[48:51], v[136:139], a[104:107], v[48:51]
    ds_read_b128 v[156:159], v9 offset:30976
    buffer_load_dwordx4 a[252:255], v7, s[32:35], s57 offen offset:256 sc1
    v_mfma_f32_16x16x32_bf16 v[52:55], v[136:139], a[108:111], v[52:55]
    s_waitcnt vmcnt(17)
    buffer_store_dword v4, v245, s[32:35], s6 offen offset:3072 sc1
    v_mfma_f32_16x16x32_bf16 v[60:63], v[140:143], a[108:111], v[60:63]
    s_barrier
    v_mfma_f32_16x16x32_bf16 v[56:59], v[140:143], a[104:107], v[56:59]
    ds_read_b128 v[128:131], v212 offset:0
    s_waitcnt lgkmcnt(3)
    v_mfma_f32_16x16x32_bf16 v[48:51], v[144:147], a[112:115], v[48:51]
    ds_read_b128 v[132:135], v212 offset:256
    s_add_u32 m0, s17, 65536
    v_mfma_f32_16x16x32_bf16 v[52:55], v[144:147], a[116:119], v[52:55]
    s_add_u32 s44, s80, 16384
    buffer_load_dwordx4 v2, s[32:35], s44 offen sc1 lds
    v_mfma_f32_16x16x32_bf16 v[60:63], v[148:151], a[116:119], v[60:63]
    ds_read_b128 v[136:139], v212 offset:2048
    v_mfma_f32_16x16x32_bf16 v[56:59], v[148:151], a[112:115], v[56:59]
    s_waitcnt lgkmcnt(3)
    v_mfma_f32_16x16x32_bf16 v[48:51], v[152:155], a[120:123], v[48:51]
    ds_read_b128 v[140:143], v212 offset:2304
    buffer_load_dwordx4 v2, s[32:35], s44 offen offset:1024 sc1 lds
    v_mfma_f32_16x16x32_bf16 v[52:55], v[152:155], a[124:127], v[52:55]
    v_mfma_f32_16x16x32_bf16 v[60:63], v[156:159], a[124:127], v[60:63]
    ds_read_b128 v[144:147], v212 offset:4096
    v_mfma_f32_16x16x32_bf16 v[56:59], v[156:159], a[120:123], v[56:59]
    v_mfma_f32_16x16x32_bf16 v[48:51], v[168:171], v[176:179], v[48:51]
    v_mfma_f32_16x16x32_bf16 v[52:55], v[168:171], v[228:231], v[52:55]
    v_mfma_f32_16x16x32_bf16 v[60:63], v[220:223], v[228:231], v[60:63]
    v_mfma_f32_16x16x32_bf16 v[56:59], v[220:223], v[176:179], v[56:59]
    s_waitcnt lgkmcnt(3)
    v_mfma_f32_16x16x32_bf16 v[64:67], v[128:131], a[0:3], 0
    ds_read_b128 v[148:151], v212 offset:4352
    s_add_u32 m0, s17, 67584
    v_mfma_f32_16x16x32_bf16 v[68:71], v[128:131], a[4:7], 0
    s_add_u32 s44, s80, 49152
    buffer_load_dwordx4 v2, s[32:35], s44 offen sc1 lds
    v_mfma_f32_16x16x32_bf16 v[76:79], v[132:135], a[4:7], 0
    ds_read_b128 v[152:155], v212 offset:6144
    buffer_load_dwordx4 v[24:27], v2, s[32:35], s78 offen sc1
    v_mfma_f32_16x16x32_bf16 v[72:75], v[132:135], a[0:3], 0
    v_mul_f32 v184, v48, v180
    s_waitcnt lgkmcnt(3)
    v_mfma_f32_16x16x32_bf16 v[64:67], v[136:139], a[8:11], v[64:67]
    ds_read_b128 v[156:159], v212 offset:6400
    buffer_load_dwordx4 v2, s[32:35], s44 offen offset:1024 sc1 lds
    v_mfma_f32_16x16x32_bf16 v[68:71], v[136:139], a[12:15], v[68:71]
    v_mul_f32 v185, v49, v180
    v_mul_f32 v186, v50, v180
    v_mul_f32 v187, v51, v180
    v_mfma_f32_16x16x32_bf16 v[76:79], v[140:143], a[12:15], v[76:79]
    ds_read_b128 v[128:131], v212 offset:8192
    buffer_load_dwordx4 v[28:31], v2, s[32:35], s78 offen offset:1024 sc1
    v_mul_f32 v188, v52, v182
    v_mfma_f32_16x16x32_bf16 v[72:75], v[140:143], a[8:11], v[72:75]
    v_mul_f32 v189, v53, v182
    v_mul_f32 v190, v54, v182
    s_waitcnt lgkmcnt(3)
    v_mfma_f32_16x16x32_bf16 v[64:67], v[144:147], a[16:19], v[64:67]
    ds_read_b128 v[132:135], v212 offset:8448
    s_add_u32 m0, s17, 69632
    s_add_u32 s44, s80, 81920
    buffer_load_dwordx4 v2, s[32:35], s44 offen sc1 lds
    v_mfma_f32_16x16x32_bf16 v[68:71], v[144:147], a[20:23], v[68:71]
    v_mul_f32 v191, v55, v182
    v_exp_f32 v184, v184
    v_mul_f32 v48, v48, v56
    v_mfma_f32_16x16x32_bf16 v[76:79], v[148:151], a[20:23], v[76:79]
    ds_read_b128 v[136:139], v212 offset:10240
    v_exp_f32 v185, v185
    v_mfma_f32_16x16x32_bf16 v[72:75], v[148:151], a[16:19], v[72:75]
    v_mul_f32 v49, v49, v57
    v_exp_f32 v186, v186
    s_waitcnt lgkmcnt(3)
    v_mfma_f32_16x16x32_bf16 v[64:67], v[152:155], a[24:27], v[64:67]
    ds_read_b128 v[140:143], v212 offset:10496
    buffer_load_dwordx4 v2, s[32:35], s44 offen offset:1024 sc1 lds
    v_mul_f32 v50, v50, v58
    v_mfma_f32_16x16x32_bf16 v[68:71], v[152:155], a[28:31], v[68:71]
    v_exp_f32 v187, v187
    v_mul_f32 v51, v51, v59
    v_mfma_f32_16x16x32_bf16 v[76:79], v[156:159], a[28:31], v[76:79]
    ds_read_b128 v[144:147], v212 offset:12288
    v_exp_f32 v188, v188
    v_mfma_f32_16x16x32_bf16 v[72:75], v[156:159], a[24:27], v[72:75]
    v_mul_f32 v52, v52, v60
    v_exp_f32 v189, v189
    s_waitcnt lgkmcnt(3)
    v_mfma_f32_16x16x32_bf16 v[64:67], v[128:131], a[32:35], v[64:67]
    ds_read_b128 v[148:151], v212 offset:12544
    v_mul_f32 v53, v53, v61
    v_mfma_f32_16x16x32_bf16 v[68:71], v[128:131], a[36:39], v[68:71]
    v_exp_f32 v190, v190
    v_mul_f32 v54, v54, v62
    v_mfma_f32_16x16x32_bf16 v[76:79], v[132:135], a[36:39], v[76:79]
    ds_read_b128 v[152:155], v212 offset:14336
    s_add_u32 m0, s17, 71680
    s_add_u32 s44, s80, 114688
    buffer_load_dwordx4 v2, s[32:35], s44 offen sc1 lds
    v_mfma_f32_16x16x32_bf16 v[72:75], v[132:135], a[32:35], v[72:75]
    v_exp_f32 v191, v191
    v_mul_f32 v55, v55, v63
    v_fma_f32 v184, v184, v181, v181
    s_waitcnt lgkmcnt(3)
    v_mfma_f32_16x16x32_bf16 v[64:67], v[136:139], a[40:43], v[64:67]
    ds_read_b128 v[156:159], v212 offset:14592
    v_fma_f32 v185, v185, v181, v181
    v_mfma_f32_16x16x32_bf16 v[68:71], v[136:139], a[44:47], v[68:71]
    v_fma_f32 v186, v186, v181, v181
    v_rcp_f32 v184, v184
    v_mfma_f32_16x16x32_bf16 v[76:79], v[140:143], a[44:47], v[76:79]
    ds_read_b128 v[128:131], v212 offset:16384
    buffer_load_dwordx4 v2, s[32:35], s44 offen offset:1024 sc1 lds
    v_fma_f32 v187, v187, v181, v181
    v_mfma_f32_16x16x32_bf16 v[72:75], v[140:143], a[40:43], v[72:75]
    v_rcp_f32 v185, v185
    v_fma_f32 v188, v188, v183, v183
    s_waitcnt lgkmcnt(3)
    v_mfma_f32_16x16x32_bf16 v[64:67], v[144:147], a[48:51], v[64:67]
    ds_read_b128 v[132:135], v212 offset:16640
    v_rcp_f32 v186, v186
    v_mfma_f32_16x16x32_bf16 v[68:71], v[144:147], a[52:55], v[68:71]
    v_fma_f32 v189, v189, v183, v183
    v_rcp_f32 v187, v187
    v_mfma_f32_16x16x32_bf16 v[76:79], v[148:151], a[52:55], v[76:79]
    ds_read_b128 v[136:139], v212 offset:18432
    s_add_u32 m0, s17, 98304
    s_add_u32 s44, s80, 18432
    buffer_load_dwordx4 v2, s[32:35], s44 offen sc1 lds
    v_mfma_f32_16x16x32_bf16 v[72:75], v[148:151], a[48:51], v[72:75]
    v_fma_f32 v190, v190, v183, v183
    v_rcp_f32 v188, v188
    v_fma_f32 v191, v191, v183, v183
    s_waitcnt lgkmcnt(3)
    v_mfma_f32_16x16x32_bf16 v[64:67], v[152:155], a[56:59], v[64:67]
    ds_read_b128 v[140:143], v212 offset:18688
    buffer_load_dword v5, v247, s[32:35], s4 offen sc1
    v_rcp_f32 v189, v189
    v_mfma_f32_16x16x32_bf16 v[68:71], v[152:155], a[60:63], v[68:71]
    v_mul_f32 v48, v48, v184
    v_rcp_f32 v190, v190
    v_mfma_f32_16x16x32_bf16 v[76:79], v[156:159], a[60:63], v[76:79]
    ds_read_b128 v[144:147], v212 offset:20480
    v_mul_f32 v49, v49, v185
    v_mfma_f32_16x16x32_bf16 v[72:75], v[156:159], a[56:59], v[72:75]
    v_rcp_f32 v191, v191
    v_mul_f32 v50, v50, v186
    s_waitcnt lgkmcnt(3)
    v_mfma_f32_16x16x32_bf16 v[64:67], v[128:131], a[64:67], v[64:67]
    ds_read_b128 v[148:151], v212 offset:20736
    buffer_load_dwordx4 v2, s[32:35], s44 offen offset:1024 sc1 lds
    v_mov_b32 v172, v165
    v_mfma_f32_16x16x32_bf16 v[68:71], v[128:131], a[68:71], v[68:71]
    v_mul_f32 v51, v51, v187
    v_mul_f32 v52, v52, v188
    v_mul_f32 v53, v53, v189
    v_mfma_f32_16x16x32_bf16 v[76:79], v[132:135], a[68:71], v[76:79]
    ds_read_b128 v[152:155], v212 offset:22528
    v_mov_b32 v224, v218
    v_mul_f32 v54, v54, v190
    v_mfma_f32_16x16x32_bf16 v[72:75], v[132:135], a[64:67], v[72:75]
    v_mul_f32 v55, v55, v191
    v_cvt_pk_bf16_f32 v192, v48, v49
    s_waitcnt lgkmcnt(3)
    v_mfma_f32_16x16x32_bf16 v[64:67], v[136:139], a[72:75], v[64:67]
    ds_read_b128 v[156:159], v212 offset:22784
    s_add_u32 m0, s17, 100352
    s_add_u32 s44, s80, 51200
    buffer_load_dwordx4 v2, s[32:35], s44 offen sc1 lds
    v_mfma_f32_16x16x32_bf16 v[68:71], v[136:139], a[76:79], v[68:71]
    v_cvt_pk_bf16_f32 v194, v52, v53
    v_cvt_pk_bf16_f32 v193, v50, v51
    v_cvt_pk_bf16_f32 v195, v54, v55
    v_mfma_f32_16x16x32_bf16 v[76:79], v[140:143], a[76:79], v[76:79]
    ds_read_b128 v[128:131], v212 offset:24576
    v_permlane16_swap_b32 v192, v194
    v_mfma_f32_16x16x32_bf16 v[72:75], v[140:143], a[72:75], v[72:75]
    v_permlane16_swap_b32 v193, v195
    buffer_store_dwordx4 v[192:195], v2, s[32:35], s83 offen offset:0 sc1
    s_waitcnt lgkmcnt(3)
    v_mfma_f32_16x16x32_bf16 v[64:67], v[144:147], a[80:83], v[64:67]
    ds_read_b128 v[132:135], v212 offset:24832
    buffer_load_dwordx4 v2, s[32:35], s44 offen offset:1024 sc1 lds
    v_mfma_f32_16x16x32_bf16 v[68:71], v[144:147], a[84:87], v[68:71]
    v_mfma_f32_16x16x32_bf16 v[76:79], v[148:151], a[84:87], v[76:79]
    ds_read_b128 v[136:139], v212 offset:26624
    v_mfma_f32_16x16x32_bf16 v[72:75], v[148:151], a[80:83], v[72:75]
    s_waitcnt lgkmcnt(3)
    v_mfma_f32_16x16x32_bf16 v[64:67], v[152:155], a[88:91], v[64:67]
    ds_read_b128 v[140:143], v212 offset:26880
    s_add_u32 m0, s17, 102400
    v_mfma_f32_16x16x32_bf16 v[68:71], v[152:155], a[92:95], v[68:71]
    s_add_u32 s44, s80, 83968
    buffer_load_dwordx4 v2, s[32:35], s44 offen sc1 lds
    v_mfma_f32_16x16x32_bf16 v[76:79], v[156:159], a[92:95], v[76:79]
    ds_read_b128 v[144:147], v212 offset:28672
    v_mfma_f32_16x16x32_bf16 v[72:75], v[156:159], a[88:91], v[72:75]
    s_waitcnt lgkmcnt(3)
    v_mfma_f32_16x16x32_bf16 v[64:67], v[128:131], a[96:99], v[64:67]
    ds_read_b128 v[148:151], v212 offset:28928
    v_mfma_f32_16x16x32_bf16 v[68:71], v[128:131], a[100:103], v[68:71]
    v_mfma_f32_16x16x32_bf16 v[76:79], v[132:135], a[100:103], v[76:79]
    ds_read_b128 v[152:155], v212 offset:30720
    buffer_load_dwordx4 v2, s[32:35], s44 offen offset:1024 sc1 lds
    v_mfma_f32_16x16x32_bf16 v[72:75], v[132:135], a[96:99], v[72:75]
    s_waitcnt lgkmcnt(3)
    v_mfma_f32_16x16x32_bf16 v[64:67], v[136:139], a[104:107], v[64:67]
    ds_read_b128 v[156:159], v212 offset:30976
    v_mfma_f32_16x16x32_bf16 v[68:71], v[136:139], a[108:111], v[68:71]
    v_mfma_f32_16x16x32_bf16 v[76:79], v[140:143], a[108:111], v[76:79]
    s_waitcnt vmcnt(28)
    s_barrier
    ds_read_b128 v[128:131], v212 offset:32768
    v_mfma_f32_16x16x32_bf16 v[72:75], v[140:143], a[104:107], v[72:75]
    s_add_u32 m0, s17, 104448
    s_add_u32 s44, s80, 116736
    buffer_load_dwordx4 v2, s[32:35], s44 offen sc1 lds
    s_waitcnt lgkmcnt(3)
    v_mfma_f32_16x16x32_bf16 v[64:67], v[144:147], a[112:115], v[64:67]
    ds_read_b128 v[132:135], v212 offset:33024
    v_mfma_f32_16x16x32_bf16 v[68:71], v[144:147], a[116:119], v[68:71]
    v_mfma_f32_16x16x32_bf16 v[76:79], v[148:151], a[116:119], v[76:79]
    ds_read_b128 v[136:139], v212 offset:34816
    buffer_load_dwordx4 v2, s[32:35], s44 offen offset:1024 sc1 lds
    v_mfma_f32_16x16x32_bf16 v[72:75], v[148:151], a[112:115], v[72:75]
    s_waitcnt lgkmcnt(3)
    v_mfma_f32_16x16x32_bf16 v[64:67], v[152:155], a[120:123], v[64:67]
    ds_read_b128 v[140:143], v212 offset:35072
    v_mfma_f32_16x16x32_bf16 v[68:71], v[152:155], a[124:127], v[68:71]
    v_mfma_f32_16x16x32_bf16 v[76:79], v[156:159], a[124:127], v[76:79]
    ds_read_b128 v[144:147], v212 offset:36864
    v_mfma_f32_16x16x32_bf16 v[72:75], v[156:159], a[120:123], v[72:75]
    v_mfma_f32_16x16x32_bf16 v[64:67], v[172:175], v[176:179], v[64:67]
    v_mfma_f32_16x16x32_bf16 v[68:71], v[172:175], v[228:231], v[68:71]
    v_mfma_f32_16x16x32_bf16 v[76:79], v[224:227], v[228:231], v[76:79]
    v_mfma_f32_16x16x32_bf16 v[72:75], v[224:227], v[176:179], v[72:75]
    s_waitcnt lgkmcnt(3)
    v_mfma_f32_16x16x32_bf16 v[80:83], v[128:131], a[0:3], 0
    ds_read_b128 v[148:151], v212 offset:37120
    v_mfma_f32_16x16x32_bf16 v[84:87], v[128:131], a[4:7], 0
    v_mfma_f32_16x16x32_bf16 v[92:95], v[132:135], a[4:7], 0
    ds_read_b128 v[152:155], v212 offset:38912
    v_mfma_f32_16x16x32_bf16 v[88:91], v[132:135], a[0:3], 0
    s_waitcnt vmcnt(8)
    v_cmp_gt_u32 vcc, 1, v5
    s_nop 0
    s_and_b64 vcc, vcc, 0xff
    s_cbranch_scc1 L_o_18
L_r_19:
    s_add_u32 s4, s4, 128
    s_add_u32 s5, s5, 128
    s_waitcnt lgkmcnt(3)
    v_mfma_f32_16x16x32_bf16 v[80:83], v[136:139], a[8:11], v[80:83]
    ds_read_b128 v[156:159], v212 offset:39168
    s_add_u32 s68, s81, 0
    buffer_load_dwordx4 a[0:3], v15, s[32:35], s68 offen sc1
    v_mul_f32 v196, v64, v180
    v_mfma_f32_16x16x32_bf16 v[84:87], v[136:139], a[12:15], v[84:87]
    v_mul_f32 v197, v65, v180
    v_mul_f32 v198, v66, v180
    v_mul_f32 v199, v67, v180
    v_mfma_f32_16x16x32_bf16 v[92:95], v[140:143], a[12:15], v[92:95]
    ds_read_b128 v[128:131], v212 offset:40960
    v_mul_f32 v200, v68, v182
    v_mfma_f32_16x16x32_bf16 v[88:91], v[140:143], a[8:11], v[88:91]
    v_mul_f32 v201, v69, v182
    v_mul_f32 v202, v70, v182
    s_waitcnt lgkmcnt(3)
    v_mfma_f32_16x16x32_bf16 v[80:83], v[144:147], a[16:19], v[80:83]
    ds_read_b128 v[132:135], v212 offset:41216
    buffer_load_dwordx4 a[4:7], v15, s[32:35], s68 offen offset:256 sc1
    v_mul_f32 v203, v71, v182
    v_mfma_f32_16x16x32_bf16 v[84:87], v[144:147], a[20:23], v[84:87]
    v_exp_f32 v196, v196
    v_mul_f32 v64, v64, v72
    v_mfma_f32_16x16x32_bf16 v[92:95], v[148:151], a[20:23], v[92:95]
    ds_read_b128 v[136:139], v212 offset:43008
    v_exp_f32 v197, v197
    v_mfma_f32_16x16x32_bf16 v[88:91], v[148:151], a[16:19], v[88:91]
    v_mul_f32 v65, v65, v73
    v_exp_f32 v198, v198
    s_waitcnt lgkmcnt(3)
    v_mfma_f32_16x16x32_bf16 v[80:83], v[152:155], a[24:27], v[80:83]
    ds_read_b128 v[140:143], v212 offset:43264
    s_add_u32 s68, s81, 0
    buffer_load_dwordx4 a[8:11], v42, s[32:35], s68 offen sc1
    v_mul_f32 v66, v66, v74
    v_mfma_f32_16x16x32_bf16 v[84:87], v[152:155], a[28:31], v[84:87]
    v_exp_f32 v199, v199
    v_mul_f32 v67, v67, v75
    v_mfma_f32_16x16x32_bf16 v[92:95], v[156:159], a[28:31], v[92:95]
    ds_read_b128 v[144:147], v212 offset:45056
    v_exp_f32 v200, v200
    v_mfma_f32_16x16x32_bf16 v[88:91], v[156:159], a[24:27], v[88:91]
    v_mul_f32 v68, v68, v76
    v_exp_f32 v201, v201
    s_waitcnt lgkmcnt(3)
    v_mfma_f32_16x16x32_bf16 v[80:83], v[128:131], a[32:35], v[80:83]
    ds_read_b128 v[148:151], v212 offset:45312
    buffer_load_dwordx4 a[12:15], v42, s[32:35], s68 offen offset:256 sc1
    v_mul_f32 v69, v69, v77
    v_mfma_f32_16x16x32_bf16 v[84:87], v[128:131], a[36:39], v[84:87]
    v_exp_f32 v202, v202
    v_mul_f32 v70, v70, v78
    v_mfma_f32_16x16x32_bf16 v[92:95], v[132:135], a[36:39], v[92:95]
    ds_read_b128 v[152:155], v212 offset:47104
    v_exp_f32 v203, v203
    v_mfma_f32_16x16x32_bf16 v[88:91], v[132:135], a[32:35], v[88:91]
    v_mul_f32 v71, v71, v79
    v_fma_f32 v196, v196, v181, v181
    s_waitcnt lgkmcnt(3)
    v_mfma_f32_16x16x32_bf16 v[80:83], v[136:139], a[40:43], v[80:83]
    ds_read_b128 v[156:159], v212 offset:47360
    s_add_u32 s68, s81, 1024
    buffer_load_dwordx4 a[16:19], v15, s[32:35], s68 offen sc1
    v_fma_f32 v197, v197, v181, v181
    v_mfma_f32_16x16x32_bf16 v[84:87], v[136:139], a[44:47], v[84:87]
    v_fma_f32 v198, v198, v181, v181
    v_rcp_f32 v196, v196
    v_mfma_f32_16x16x32_bf16 v[92:95], v[140:143], a[44:47], v[92:95]
    ds_read_b128 v[128:131], v212 offset:49152
    v_fma_f32 v199, v199, v181, v181
    v_mfma_f32_16x16x32_bf16 v[88:91], v[140:143], a[40:43], v[88:91]
    v_rcp_f32 v197, v197
    v_fma_f32 v200, v200, v183, v183
    s_waitcnt lgkmcnt(3)
    v_mfma_f32_16x16x32_bf16 v[80:83], v[144:147], a[48:51], v[80:83]
    ds_read_b128 v[132:135], v212 offset:49408
    v_rcp_f32 v198, v198
    v_fma_f32 v201, v201, v183, v183
    v_mfma_f32_16x16x32_bf16 v[84:87], v[144:147], a[52:55], v[84:87]
    v_rcp_f32 v199, v199
    s_waitcnt vmcnt(10)
    buffer_store_dword v4, v245, s[32:35], s6 offen offset:3200 sc1
    v_mfma_f32_16x16x32_bf16 v[92:95], v[148:151], a[52:55], v[92:95]
    ds_read_b128 v[136:139], v212 offset:51200
    buffer_load_dwordx4 a[20:23], v15, s[32:35], s68 offen offset:256 sc1
    v_fma_f32 v202, v202, v183, v183
    v_mfma_f32_16x16x32_bf16 v[88:91], v[148:151], a[48:51], v[88:91]
    v_rcp_f32 v200, v200
    v_fma_f32 v203, v203, v183, v183
    s_waitcnt lgkmcnt(3)
    v_mfma_f32_16x16x32_bf16 v[80:83], v[152:155], a[56:59], v[80:83]
    ds_read_b128 v[140:143], v212 offset:51456
    v_rcp_f32 v201, v201
    v_mfma_f32_16x16x32_bf16 v[84:87], v[152:155], a[60:63], v[84:87]
    v_mul_f32 v64, v64, v196
    v_rcp_f32 v202, v202
    v_mfma_f32_16x16x32_bf16 v[92:95], v[156:159], a[60:63], v[92:95]
    ds_read_b128 v[144:147], v212 offset:53248
    s_add_u32 s68, s81, 1024
    buffer_load_dwordx4 a[24:27], v42, s[32:35], s68 offen sc1
    v_mul_f32 v65, v65, v197
    v_mfma_f32_16x16x32_bf16 v[88:91], v[156:159], a[56:59], v[88:91]
    v_rcp_f32 v203, v203
    v_mul_f32 v66, v66, v198
    s_waitcnt lgkmcnt(3)
    v_mfma_f32_16x16x32_bf16 v[80:83], v[128:131], a[64:67], v[80:83]
    ds_read_b128 v[148:151], v212 offset:53504
    v_mov_b32 v168, v166
    v_mul_f32 v67, v67, v199
    v_mfma_f32_16x16x32_bf16 v[84:87], v[128:131], a[68:71], v[84:87]
    v_mul_f32 v68, v68, v200
    v_mul_f32 v69, v69, v201
    v_mfma_f32_16x16x32_bf16 v[92:95], v[132:135], a[68:71], v[92:95]
    ds_read_b128 v[152:155], v212 offset:55296
    buffer_load_dwordx4 a[28:31], v42, s[32:35], s68 offen offset:256 sc1
    v_mov_b32 v220, v219
    v_mfma_f32_16x16x32_bf16 v[88:91], v[132:135], a[64:67], v[88:91]
    v_mul_f32 v70, v70, v202
    v_mul_f32 v71, v71, v203
    v_cvt_pk_bf16_f32 v204, v64, v65
    s_waitcnt lgkmcnt(3)
    v_mfma_f32_16x16x32_bf16 v[80:83], v[136:139], a[72:75], v[80:83]
    ds_read_b128 v[156:159], v212 offset:55552
    v_cvt_pk_bf16_f32 v206, v68, v69
    v_mfma_f32_16x16x32_bf16 v[84:87], v[136:139], a[76:79], v[84:87]
    v_cvt_pk_bf16_f32 v205, v66, v67
    v_cvt_pk_bf16_f32 v207, v70, v71
    v_mfma_f32_16x16x32_bf16 v[92:95], v[140:143], a[76:79], v[92:95]
    ds_read_b128 v[128:131], v212 offset:57344
    s_add_u32 s68, s81, 2048
    buffer_load_dwordx4 a[32:35], v15, s[32:35], s68 offen sc1
    v_mfma_f32_16x16x32_bf16 v[88:91], v[140:143], a[72:75], v[88:91]
    v_permlane16_swap_b32 v204, v206
    v_permlane16_swap_b32 v205, v207
    buffer_store_dwordx4 v[204:207], v2, s[32:35], s83 offen offset:1024 sc1
    s_waitcnt lgkmcnt(3)
    v_mfma_f32_16x16x32_bf16 v[80:83], v[144:147], a[80:83], v[80:83]
    ds_read_b128 v[132:135], v212 offset:57600
    v_mfma_f32_16x16x32_bf16 v[84:87], v[144:147], a[84:87], v[84:87]
    v_mfma_f32_16x16x32_bf16 v[92:95], v[148:151], a[84:87], v[92:95]
    ds_read_b128 v[136:139], v212 offset:59392
    buffer_load_dwordx4 a[36:39], v15, s[32:35], s68 offen offset:256 sc1
    v_permlane16_swap_b32 v24, v26
    v_mfma_f32_16x16x32_bf16 v[88:91], v[148:151], a[80:83], v[88:91]
    v_permlane16_swap_b32 v25, v27
    v_permlane16_swap_b32 v28, v30
    s_waitcnt lgkmcnt(3)
    v_mfma_f32_16x16x32_bf16 v[80:83], v[152:155], a[88:91], v[80:83]
    ds_read_b128 v[140:143], v212 offset:59648
    v_permlane16_swap_b32 v29, v31
    v_mfma_f32_16x16x32_bf16 v[84:87], v[152:155], a[92:95], v[84:87]
    v_lshlrev_b32 v48, 16, v24
    v_and_b32 v49, s60, v24
    v_mfma_f32_16x16x32_bf16 v[92:95], v[156:159], a[92:95], v[92:95]
    ds_read_b128 v[144:147], v212 offset:61440
    v_lshlrev_b32 v50, 16, v25
    v_mfma_f32_16x16x32_bf16 v[88:91], v[156:159], a[88:91], v[88:91]
    v_and_b32 v51, s60, v25
    s_waitcnt lgkmcnt(3)
    v_mfma_f32_16x16x32_bf16 v[80:83], v[128:131], a[96:99], v[80:83]
    ds_read_b128 v[148:151], v212 offset:61696
    s_add_u32 s68, s81, 2048
    buffer_load_dwordx4 a[40:43], v42, s[32:35], s68 offen sc1
    v_mfma_f32_16x16x32_bf16 v[84:87], v[128:131], a[100:103], v[84:87]
    v_lshlrev_b32 v52, 16, v26
    v_and_b32 v53, s60, v26
    v_lshlrev_b32 v54, 16, v27
    v_mfma_f32_16x16x32_bf16 v[92:95], v[132:135], a[100:103], v[92:95]
    ds_read_b128 v[152:155], v212 offset:63488
    v_and_b32 v55, s60, v27
    v_mfma_f32_16x16x32_bf16 v[88:91], v[132:135], a[96:99], v[88:91]
    v_lshlrev_b32 v56, 16, v28
    v_and_b32 v57, s60, v28
    s_waitcnt lgkmcnt(3)
    v_mfma_f32_16x16x32_bf16 v[80:83], v[136:139], a[104:107], v[80:83]
    ds_read_b128 v[156:159], v212 offset:63744
    buffer_load_dwordx4 a[44:47], v42, s[32:35], s68 offen offset:256 sc1
    v_mfma_f32_16x16x32_bf16 v[84:87], v[136:139], a[108:111], v[84:87]
    v_lshlrev_b32 v58, 16, v29
    v_and_b32 v59, s60, v29
    v_mfma_f32_16x16x32_bf16 v[92:95], v[140:143], a[108:111], v[92:95]
    v_lshlrev_b32 v60, 16, v30
    v_and_b32 v61, s60, v30
    v_mfma_f32_16x16x32_bf16 v[88:91], v[140:143], a[104:107], v[88:91]
    v_lshlrev_b32 v62, 16, v31
    s_waitcnt lgkmcnt(2)
    v_mfma_f32_16x16x32_bf16 v[80:83], v[144:147], a[112:115], v[80:83]
    s_add_u32 s68, s81, 32768
    buffer_load_dwordx4 a[48:51], v15, s[32:35], s68 offen sc1
    s_xor_b32 s45, s40, 0
    v_mfma_f32_16x16x32_bf16 v[84:87], v[144:147], a[116:119], v[84:87]
    s_mul_i32 s45, s45, 12288
    v_and_b32 v63, s60, v31
    v_mfma_f32_16x16x32_bf16 v[92:95], v[148:151], a[116:119], v[92:95]
    v_add_u32 v36, s45, v2
    s_xor_b32 s45, s40, 1
    v_mfma_f32_16x16x32_bf16 v[88:91], v[148:151], a[112:115], v[88:91]
    s_waitcnt lgkmcnt(1)
    v_mfma_f32_16x16x32_bf16 v[80:83], v[152:155], a[120:123], v[80:83]
    buffer_load_dwordx4 a[52:55], v15, s[32:35], s68 offen offset:256 sc1
    s_mul_i32 s45, s45, 12288
    v_mfma_f32_16x16x32_bf16 v[84:87], v[152:155], a[124:127], v[84:87]
    v_add_u32 v37, s45, v2
    s_xor_b32 s45, s40, 2
    s_waitcnt lgkmcnt(0)
    v_mfma_f32_16x16x32_bf16 v[92:95], v[156:159], a[124:127], v[92:95]
    s_mul_i32 s45, s45, 12288
    v_add_u32 v38, s45, v2
    v_mfma_f32_16x16x32_bf16 v[88:91], v[156:159], a[120:123], v[88:91]
    s_xor_b32 s45, s40, 3
    v_mfma_f32_16x16x32_bf16 v[80:83], v[168:171], v[176:179], v[80:83]
    v_mfma_f32_16x16x32_bf16 v[84:87], v[168:171], v[228:231], v[84:87]
    v_mfma_f32_16x16x32_bf16 v[92:95], v[220:223], v[228:231], v[92:95]
    v_mfma_f32_16x16x32_bf16 v[88:91], v[220:223], v[176:179], v[88:91]
    s_mul_i32 s45, s45, 12288
    v_add_u32 v39, s45, v2
    s_waitcnt vmcnt(15)
    v_mfma_f32_16x16x32_bf16 v[48:51], a[128:131], a[0:3], v[48:51]
    s_add_u32 s68, s81, 32768
    buffer_load_dwordx4 a[56:59], v42, s[32:35], s68 offen sc1
    s_waitcnt vmcnt(15)
    v_mfma_f32_16x16x32_bf16 v[52:55], a[128:131], a[4:7], v[52:55]
    v_mul_f32 v184, v80, v180
    v_mfma_f32_16x16x32_bf16 v[60:63], a[132:135], a[4:7], v[60:63]
    v_mul_f32 v185, v81, v180
    v_mul_f32 v186, v82, v180
    v_mfma_f32_16x16x32_bf16 v[56:59], a[132:135], a[0:3], v[56:59]
    v_mul_f32 v187, v83, v180
    v_mul_f32 v188, v84, v182
    v_mul_f32 v189, v85, v182
    v_mfma_f32_16x16x32_bf16 v[64:67], a[136:139], a[0:3], 0
    buffer_load_dwordx4 a[60:63], v42, s[32:35], s68 offen offset:256 sc1
    v_mul_f32 v190, v86, v182
    v_mul_f32 v191, v87, v182
    v_mfma_f32_16x16x32_bf16 v[68:71], a[136:139], a[4:7], 0
    v_exp_f32 v184, v184
    v_mul_f32 v80, v80, v88
    v_exp_f32 v185, v185
    v_mfma_f32_16x16x32_bf16 v[76:79], a[140:143], a[4:7], 0
    v_mul_f32 v81, v81, v89
    v_exp_f32 v186, v186
    v_mul_f32 v82, v82, v90
    v_mfma_f32_16x16x32_bf16 v[72:75], a[140:143], a[0:3], 0
    v_exp_f32 v187, v187
    v_mul_f32 v83, v83, v91
    v_exp_f32 v188, v188
    s_waitcnt vmcnt(15)
    v_mfma_f32_16x16x32_bf16 v[112:115], a[136:139], a[8:11], 0
    s_add_u32 s68, s81, 33792
    buffer_load_dwordx4 a[64:67], v15, s[32:35], s68 offen sc1
    v_mul_f32 v84, v84, v92
    v_exp_f32 v189, v189
    s_waitcnt vmcnt(15)
    v_mfma_f32_16x16x32_bf16 v[116:119], a[136:139], a[12:15], 0
    v_mul_f32 v85, v85, v93
    v_exp_f32 v190, v190
    v_mul_f32 v86, v86, v94
    v_mfma_f32_16x16x32_bf16 v[124:127], a[140:143], a[12:15], 0
    v_exp_f32 v191, v191
    v_mul_f32 v87, v87, v95
    v_fma_f32 v184, v184, v181, v181
    v_mfma_f32_16x16x32_bf16 v[120:123], a[140:143], a[8:11], 0
    v_fma_f32 v185, v185, v181, v181
    v_fma_f32 v186, v186, v181, v181
    v_rcp_f32 v184, v184
    v_mfma_f32_16x16x32_bf16 v[96:99], a[128:131], a[8:11], 0
    buffer_load_dword v5, v247, s[32:35], s4 offen sc1
    buffer_load_dwordx4 a[68:71], v15, s[32:35], s68 offen offset:256 sc1
    v_fma_f32 v187, v187, v181, v181
    v_rcp_f32 v185, v185
    v_mfma_f32_16x16x32_bf16 v[100:103], a[128:131], a[12:15], 0
    v_fma_f32 v188, v188, v183, v183
    v_rcp_f32 v186, v186
    v_fma_f32 v189, v189, v183, v183
    v_mfma_f32_16x16x32_bf16 v[108:111], a[132:135], a[12:15], 0
    v_rcp_f32 v187, v187
    v_fma_f32 v190, v190, v183, v183
    v_rcp_f32 v188, v188
    v_mfma_f32_16x16x32_bf16 v[104:107], a[132:135], a[8:11], 0
    v_fma_f32 v191, v191, v183, v183
    v_rcp_f32 v189, v189
    v_mul_f32 v80, v80, v184
    s_waitcnt vmcnt(16)
    v_mfma_f32_16x16x32_bf16 v[48:51], a[144:147], a[16:19], v[48:51]
    s_add_u32 s68, s81, 33792
    buffer_load_dwordx4 a[72:75], v42, s[32:35], s68 offen sc1
    v_rcp_f32 v190, v190
    v_mul_f32 v81, v81, v185
    s_waitcnt vmcnt(15)
    v_mfma_f32_16x16x32_bf16 v[52:55], a[144:147], a[20:23], v[52:55]
    v_rcp_f32 v191, v191
    v_mul_f32 v82, v82, v186
    v_mul_f32 v83, v83, v187
    v_mfma_f32_16x16x32_bf16 v[60:63], a[148:151], a[20:23], v[60:63]
    v_mul_f32 v84, v84, v188
    v_mul_f32 v85, v85, v189
    v_mul_f32 v86, v86, v190
    v_mfma_f32_16x16x32_bf16 v[56:59], a[148:151], a[16:19], v[56:59]
    v_mul_f32 v87, v87, v191
    v_cvt_pk_bf16_f32 v192, v80, v81
    v_cvt_pk_bf16_f32 v194, v84, v85
    v_mfma_f32_16x16x32_bf16 v[64:67], a[152:155], a[16:19], v[64:67]
    v_cvt_pk_bf16_f32 v193, v82, v83
    v_cvt_pk_bf16_f32 v195, v86, v87
    v_mfma_f32_16x16x32_bf16 v[68:71], a[152:155], a[20:23], v[68:71]
    v_permlane16_swap_b32 v192, v194
    v_permlane16_swap_b32 v193, v195
    buffer_store_dwordx4 v[192:195], v2, s[32:35], s83 offen offset:2048 sc1
    v_mfma_f32_16x16x32_bf16 v[76:79], a[156:159], a[20:23], v[76:79]
    buffer_load_dwordx4 a[76:79], v42, s[32:35], s68 offen offset:256 sc1
    v_mfma_f32_16x16x32_bf16 v[72:75], a[156:159], a[16:19], v[72:75]
    s_waitcnt vmcnt(16)
    v_mfma_f32_16x16x32_bf16 v[112:115], a[152:155], a[24:27], v[112:115]
    s_waitcnt vmcnt(13)
    buffer_store_dword v4, v245, s[32:35], s6 offen offset:3328 sc1
    v_mfma_f32_16x16x32_bf16 v[116:119], a[152:155], a[28:31], v[116:119]
    v_mfma_f32_16x16x32_bf16 v[124:127], a[156:159], a[28:31], v[124:127]
    s_add_u32 s68, s81, 34816
    buffer_load_dwordx4 a[80:83], v15, s[32:35], s68 offen sc1
    v_mfma_f32_16x16x32_bf16 v[120:123], a[156:159], a[24:27], v[120:123]
    v_mfma_f32_16x16x32_bf16 v[96:99], a[144:147], a[24:27], v[96:99]
    v_mfma_f32_16x16x32_bf16 v[100:103], a[144:147], a[28:31], v[100:103]
    v_mfma_f32_16x16x32_bf16 v[108:111], a[148:151], a[28:31], v[108:111]
    buffer_load_dwordx4 a[84:87], v15, s[32:35], s68 offen offset:256 sc1
    v_mfma_f32_16x16x32_bf16 v[104:107], a[148:151], a[24:27], v[104:107]
    v_mfma_f32_16x16x32_bf16 v[48:51], a[160:163], a[32:35], v[48:51]
    s_waitcnt vmcnt(15)
    v_mfma_f32_16x16x32_bf16 v[52:55], a[160:163], a[36:39], v[52:55]
    v_mfma_f32_16x16x32_bf16 v[60:63], a[164:167], a[36:39], v[60:63]
    s_add_u32 s68, s81, 34816
    buffer_load_dwordx4 a[88:91], v42, s[32:35], s68 offen sc1
    v_mfma_f32_16x16x32_bf16 v[56:59], a[164:167], a[32:35], v[56:59]
    v_mfma_f32_16x16x32_bf16 v[64:67], a[168:171], a[32:35], v[64:67]
    v_mfma_f32_16x16x32_bf16 v[68:71], a[168:171], a[36:39], v[68:71]
    v_mfma_f32_16x16x32_bf16 v[76:79], a[172:175], a[36:39], v[76:79]
    buffer_load_dwordx4 a[92:95], v42, s[32:35], s68 offen offset:256 sc1
    v_mfma_f32_16x16x32_bf16 v[72:75], a[172:175], a[32:35], v[72:75]
    s_waitcnt vmcnt(16)
    v_mfma_f32_16x16x32_bf16 v[112:115], a[168:171], a[40:43], v[112:115]
    s_waitcnt vmcnt(15)
    v_mfma_f32_16x16x32_bf16 v[116:119], a[168:171], a[44:47], v[116:119]
    v_mfma_f32_16x16x32_bf16 v[124:127], a[172:175], a[44:47], v[124:127]
    v_mfma_f32_16x16x32_bf16 v[120:123], a[172:175], a[40:43], v[120:123]
    v_mfma_f32_16x16x32_bf16 v[96:99], a[160:163], a[40:43], v[96:99]
    v_mfma_f32_16x16x32_bf16 v[100:103], a[160:163], a[44:47], v[100:103]
    s_waitcnt vmcnt(9)
    v_cmp_gt_u32 vcc, 1, v5
    s_nop 0
    s_and_b64 vcc, vcc, 0xff
    s_cbranch_scc1 L_o_21
L_r_22:
    s_add_u32 s4, s4, 128
    s_add_u32 s5, s5, 128
    v_mfma_f32_16x16x32_bf16 v[108:111], a[164:167], a[44:47], v[108:111]
    s_add_u32 s68, s81, 3072
    buffer_load_dwordx4 a[96:99], v15, s[32:35], s68 offen sc1
    v_mfma_f32_16x16x32_bf16 v[104:107], a[164:167], a[40:43], v[104:107]
    v_mfma_f32_16x16x32_bf16 v[48:51], a[176:179], a[48:51], v[48:51]
    buffer_load_dwordx4 a[100:103], v15, s[32:35], s68 offen offset:256 sc1
    v_mfma_f32_16x16x32_bf16 v[52:55], a[176:179], a[52:55], v[52:55]
    v_mfma_f32_16x16x32_bf16 v[60:63], a[180:183], a[52:55], v[60:63]
    v_mfma_f32_16x16x32_bf16 v[56:59], a[180:183], a[48:51], v[56:59]
    v_mfma_f32_16x16x32_bf16 v[64:67], a[184:187], a[48:51], v[64:67]
    s_add_u32 s68, s81, 3072
    buffer_load_dwordx4 a[104:107], v42, s[32:35], s68 offen sc1
    v_mfma_f32_16x16x32_bf16 v[68:71], a[184:187], a[52:55], v[68:71]
    v_mfma_f32_16x16x32_bf16 v[76:79], a[188:191], a[52:55], v[76:79]
    v_mfma_f32_16x16x32_bf16 v[72:75], a[188:191], a[48:51], v[72:75]
    v_mfma_f32_16x16x32_bf16 v[112:115], a[184:187], a[56:59], v[112:115]
    buffer_load_dwordx4 a[108:111], v42, s[32:35], s68 offen offset:256 sc1
    v_mfma_f32_16x16x32_bf16 v[116:119], a[184:187], a[60:63], v[116:119]
    v_mfma_f32_16x16x32_bf16 v[124:127], a[188:191], a[60:63], v[124:127]
    v_mfma_f32_16x16x32_bf16 v[120:123], a[188:191], a[56:59], v[120:123]
    v_mfma_f32_16x16x32_bf16 v[96:99], a[176:179], a[56:59], v[96:99]
    s_add_u32 s68, s81, 35840
    buffer_load_dwordx4 a[112:115], v15, s[32:35], s68 offen sc1
    v_mfma_f32_16x16x32_bf16 v[100:103], a[176:179], a[60:63], v[100:103]
    v_mfma_f32_16x16x32_bf16 v[108:111], a[180:183], a[60:63], v[108:111]
    v_mfma_f32_16x16x32_bf16 v[104:107], a[180:183], a[56:59], v[104:107]
    v_mfma_f32_16x16x32_bf16 v[48:51], a[192:195], a[64:67], v[48:51]
    buffer_load_dwordx4 a[116:119], v15, s[32:35], s68 offen offset:256 sc1
    s_waitcnt vmcnt(14)
    v_mfma_f32_16x16x32_bf16 v[52:55], a[192:195], a[68:71], v[52:55]
    v_mfma_f32_16x16x32_bf16 v[60:63], a[196:199], a[68:71], v[60:63]
    v_mfma_f32_16x16x32_bf16 v[56:59], a[196:199], a[64:67], v[56:59]
    v_mfma_f32_16x16x32_bf16 v[64:67], a[200:203], a[64:67], v[64:67]
    s_add_u32 s68, s81, 35840
    buffer_load_dwordx4 a[120:123], v42, s[32:35], s68 offen sc1
    v_mfma_f32_16x16x32_bf16 v[68:71], a[200:203], a[68:71], v[68:71]
    v_mfma_f32_16x16x32_bf16 v[76:79], a[204:207], a[68:71], v[76:79]
    v_mfma_f32_16x16x32_bf16 v[72:75], a[204:207], a[64:67], v[72:75]
    s_waitcnt vmcnt(14)
    v_mfma_f32_16x16x32_bf16 v[112:115], a[200:203], a[72:75], v[112:115]
    buffer_load_dwordx4 a[124:127], v42, s[32:35], s68 offen offset:256 sc1
    s_waitcnt vmcnt(13)
    v_mfma_f32_16x16x32_bf16 v[116:119], a[200:203], a[76:79], v[116:119]
    v_mfma_f32_16x16x32_bf16 v[124:127], a[204:207], a[76:79], v[124:127]
    buffer_load_dword v5, v247, s[32:35], s4 offen sc1
    v_mfma_f32_16x16x32_bf16 v[120:123], a[204:207], a[72:75], v[120:123]
    v_mfma_f32_16x16x32_bf16 v[96:99], a[192:195], a[72:75], v[96:99]
    buffer_store_dword v4, v245, s[32:35], s6 offen offset:3456 sc1
    v_mfma_f32_16x16x32_bf16 v[100:103], a[192:195], a[76:79], v[100:103]
    s_add_u32 s68, s81, 4096
    buffer_load_dwordx4 a[0:3], v15, s[32:35], s68 offen sc1
    v_mfma_f32_16x16x32_bf16 v[108:111], a[196:199], a[76:79], v[108:111]
    v_mfma_f32_16x16x32_bf16 v[104:107], a[196:199], a[72:75], v[104:107]
    s_waitcnt vmcnt(14)
    v_mfma_f32_16x16x32_bf16 v[48:51], a[208:211], a[80:83], v[48:51]
    s_barrier
    buffer_load_dwordx4 a[4:7], v15, s[32:35], s68 offen offset:256 sc1
    s_waitcnt vmcnt(14)
    v_mfma_f32_16x16x32_bf16 v[52:55], a[208:211], a[84:87], v[52:55]
    v_mfma_f32_16x16x32_bf16 v[60:63], a[212:215], a[84:87], v[60:63]
    v_mfma_f32_16x16x32_bf16 v[56:59], a[212:215], a[80:83], v[56:59]
    v_mfma_f32_16x16x32_bf16 v[64:67], a[216:219], a[80:83], v[64:67]
    s_add_u32 s68, s81, 4096
    buffer_load_dwordx4 a[8:11], v42, s[32:35], s68 offen sc1
    v_mfma_f32_16x16x32_bf16 v[68:71], a[216:219], a[84:87], v[68:71]
    v_mfma_f32_16x16x32_bf16 v[76:79], a[220:223], a[84:87], v[76:79]
    v_mfma_f32_16x16x32_bf16 v[72:75], a[220:223], a[80:83], v[72:75]
    s_waitcnt vmcnt(14)
    v_mfma_f32_16x16x32_bf16 v[112:115], a[216:219], a[88:91], v[112:115]
    buffer_load_dwordx4 a[12:15], v42, s[32:35], s68 offen offset:256 sc1
    s_waitcnt vmcnt(14)
    v_mfma_f32_16x16x32_bf16 v[116:119], a[216:219], a[92:95], v[116:119]
    v_mfma_f32_16x16x32_bf16 v[124:127], a[220:223], a[92:95], v[124:127]
    v_mfma_f32_16x16x32_bf16 v[120:123], a[220:223], a[88:91], v[120:123]
    v_mfma_f32_16x16x32_bf16 v[96:99], a[208:211], a[88:91], v[96:99]
    s_add_u32 s68, s81, 36864
    buffer_load_dwordx4 a[16:19], v15, s[32:35], s68 offen sc1
    v_mfma_f32_16x16x32_bf16 v[100:103], a[208:211], a[92:95], v[100:103]
    v_mfma_f32_16x16x32_bf16 v[108:111], a[212:215], a[92:95], v[108:111]
    v_mfma_f32_16x16x32_bf16 v[104:107], a[212:215], a[88:91], v[104:107]
    s_waitcnt vmcnt(14)
    v_mfma_f32_16x16x32_bf16 v[48:51], a[224:227], a[96:99], v[48:51]
    buffer_load_dwordx4 a[20:23], v15, s[32:35], s68 offen offset:256 sc1
    s_waitcnt vmcnt(14)
    v_mfma_f32_16x16x32_bf16 v[52:55], a[224:227], a[100:103], v[52:55]
    v_mfma_f32_16x16x32_bf16 v[60:63], a[228:231], a[100:103], v[60:63]
    v_mfma_f32_16x16x32_bf16 v[56:59], a[228:231], a[96:99], v[56:59]
    v_mfma_f32_16x16x32_bf16 v[64:67], a[232:235], a[96:99], v[64:67]
    s_add_u32 s68, s81, 36864
    buffer_load_dwordx4 a[24:27], v42, s[32:35], s68 offen sc1
    v_mfma_f32_16x16x32_bf16 v[68:71], a[232:235], a[100:103], v[68:71]
    v_mfma_f32_16x16x32_bf16 v[76:79], a[236:239], a[100:103], v[76:79]
    v_mfma_f32_16x16x32_bf16 v[72:75], a[236:239], a[96:99], v[72:75]
    s_waitcnt vmcnt(14)
    v_mfma_f32_16x16x32_bf16 v[112:115], a[232:235], a[104:107], v[112:115]
    buffer_load_dwordx4 a[28:31], v42, s[32:35], s68 offen offset:256 sc1
    s_waitcnt vmcnt(14)
    v_mfma_f32_16x16x32_bf16 v[116:119], a[232:235], a[108:111], v[116:119]
    v_mfma_f32_16x16x32_bf16 v[124:127], a[236:239], a[108:111], v[124:127]
    v_mfma_f32_16x16x32_bf16 v[120:123], a[236:239], a[104:107], v[120:123]
    v_mfma_f32_16x16x32_bf16 v[96:99], a[224:227], a[104:107], v[96:99]
    v_mfma_f32_16x16x32_bf16 v[100:103], a[224:227], a[108:111], v[100:103]
    s_waitcnt vmcnt(9)
    v_cmp_gt_u32 vcc, 1, v5
    s_nop 0
    s_and_b64 vcc, vcc, 0xff
    s_cbranch_scc1 L_o_24
L_r_25:
    s_add_u32 s4, s4, 128
    s_add_u32 s5, s5, 128
    v_mfma_f32_16x16x32_bf16 v[108:111], a[228:231], a[108:111], v[108:111]
    s_add_u32 s68, s81, 5120
    buffer_load_dwordx4 a[32:35], v15, s[32:35], s68 offen sc1
    v_mfma_f32_16x16x32_bf16 v[104:107], a[228:231], a[104:107], v[104:107]
    buffer_load_dwordx4 a[36:39], v15, s[32:35], s68 offen offset:256 sc1
    v_mfma_f32_16x16x32_bf16 v[48:51], a[240:243], a[112:115], v[48:51]
    s_add_u32 s68, s81, 5120
    buffer_load_dwordx4 a[40:43], v42, s[32:35], s68 offen sc1
    v_mfma_f32_16x16x32_bf16 v[52:55], a[240:243], a[116:119], v[52:55]
    v_mfma_f32_16x16x32_bf16 v[60:63], a[244:247], a[116:119], v[60:63]
    ds_read_b128 v[128:131], v10 offset:0
    v_mfma_f32_16x16x32_bf16 v[56:59], a[244:247], a[112:115], v[56:59]
    ds_read_b128 v[132:135], v10 offset:256
    buffer_load_dwordx4 a[44:47], v42, s[32:35], s68 offen offset:256 sc1
    v_mfma_f32_16x16x32_bf16 v[64:67], a[248:251], a[112:115], v[64:67]
    s_add_u32 s68, s81, 37888
    buffer_load_dwordx4 a[48:51], v15, s[32:35], s68 offen sc1
    v_mfma_f32_16x16x32_bf16 v[68:71], a[248:251], a[116:119], v[68:71]
    v_mfma_f32_16x16x32_bf16 v[76:79], a[252:255], a[116:119], v[76:79]
    ds_read_b128 v[136:139], v11 offset:0
    ds_read_b128 v[140:143], v11 offset:256
    v_mfma_f32_16x16x32_bf16 v[72:75], a[252:255], a[112:115], v[72:75]
    buffer_load_dwordx4 a[52:55], v15, s[32:35], s68 offen offset:256 sc1
    v_mfma_f32_16x16x32_bf16 v[112:115], a[248:251], a[120:123], v[112:115]
    s_add_u32 s68, s81, 37888
    buffer_load_dwordx4 a[56:59], v42, s[32:35], s68 offen sc1
    v_mfma_f32_16x16x32_bf16 v[116:119], a[248:251], a[124:127], v[116:119]
    v_mfma_f32_16x16x32_bf16 v[124:127], a[252:255], a[124:127], v[124:127]
    buffer_load_dwordx4 a[60:63], v42, s[32:35], s68 offen offset:256 sc1
    v_mfma_f32_16x16x32_bf16 v[120:123], a[252:255], a[120:123], v[120:123]
    v_mfma_f32_16x16x32_bf16 v[96:99], a[240:243], a[120:123], v[96:99]
    buffer_load_dword v5, v247, s[32:35], s4 offen sc1
    v_mfma_f32_16x16x32_bf16 v[100:103], a[240:243], a[124:127], v[100:103]
    v_mfma_f32_16x16x32_bf16 v[108:111], a[244:247], a[124:127], v[108:111]
    s_add_u32 m0, s17, 131072
    s_add_u32 s44, s80, 20480
    v_mfma_f32_16x16x32_bf16 v[104:107], a[244:247], a[120:123], v[104:107]
    buffer_load_dwordx4 v2, s[32:35], s44 offen sc1 lds
    s_waitcnt vmcnt(17) lgkmcnt(2)
    v_mfma_f32_16x16x32_bf16 v[48:51], v[128:131], a[0:3], v[48:51]
    buffer_load_dwordx4 v2, s[32:35], s44 offen offset:1024 sc1 lds
    s_waitcnt vmcnt(17)
    v_mfma_f32_16x16x32_bf16 v[52:55], v[128:131], a[4:7], v[52:55]
    v_mfma_f32_16x16x32_bf16 v[60:63], v[132:135], a[4:7], v[60:63]
    ds_read_b128 v[144:147], v10 offset:4096
    ds_read_b128 v[148:151], v10 offset:4352
    v_mfma_f32_16x16x32_bf16 v[56:59], v[132:135], a[0:3], v[56:59]
    s_waitcnt lgkmcnt(2)
    v_mfma_f32_16x16x32_bf16 v[64:67], v[136:139], a[0:3], v[64:67]
    s_add_u32 m0, s17, 133120
    s_add_u32 s44, s80, 53248
    v_mfma_f32_16x16x32_bf16 v[68:71], v[136:139], a[4:7], v[68:71]
    buffer_load_dwordx4 v2, s[32:35], s44 offen sc1 lds
    v_mfma_f32_16x16x32_bf16 v[76:79], v[140:143], a[4:7], v[76:79]
    ds_read_b128 v[152:155], v11 offset:4096
    ds_read_b128 v[156:159], v11 offset:4352
    v_mfma_f32_16x16x32_bf16 v[72:75], v[140:143], a[0:3], v[72:75]
    buffer_load_dwordx4 v2, s[32:35], s44 offen offset:1024 sc1 lds
    s_waitcnt vmcnt(18)
    v_mfma_f32_16x16x32_bf16 v[112:115], v[136:139], a[8:11], v[112:115]
    s_waitcnt vmcnt(17)
    v_mfma_f32_16x16x32_bf16 v[116:119], v[136:139], a[12:15], v[116:119]
    v_mfma_f32_16x16x32_bf16 v[124:127], v[140:143], a[12:15], v[124:127]
    s_add_u32 m0, s17, 135168
    s_add_u32 s44, s80, 86016
    v_mfma_f32_16x16x32_bf16 v[120:123], v[140:143], a[8:11], v[120:123]
    buffer_load_dwordx4 v2, s[32:35], s44 offen sc1 lds
    v_mfma_f32_16x16x32_bf16 v[96:99], v[128:131], a[8:11], v[96:99]
    v_mfma_f32_16x16x32_bf16 v[100:103], v[128:131], a[12:15], v[100:103]
    v_mfma_f32_16x16x32_bf16 v[108:111], v[132:135], a[12:15], v[108:111]
    buffer_load_dwordx4 v2, s[32:35], s44 offen offset:1024 sc1 lds
    v_mfma_f32_16x16x32_bf16 v[104:107], v[132:135], a[8:11], v[104:107]
    s_waitcnt vmcnt(18) lgkmcnt(2)
    v_mfma_f32_16x16x32_bf16 v[48:51], v[144:147], a[16:19], v[48:51]
    s_add_u32 m0, s17, 137216
    s_add_u32 s44, s80, 118784
    s_waitcnt vmcnt(17)
    v_mfma_f32_16x16x32_bf16 v[52:55], v[144:147], a[20:23], v[52:55]
    buffer_load_dwordx4 v2, s[32:35], s44 offen sc1 lds
    v_mfma_f32_16x16x32_bf16 v[60:63], v[148:151], a[20:23], v[60:63]
    ds_read_b128 v[168:171], v10 offset:32768
    v_mfma_f32_16x16x32_bf16 v[56:59], v[148:151], a[16:19], v[56:59]
    ds_read_b128 v[172:175], v10 offset:33024
    s_waitcnt lgkmcnt(2)
    v_mfma_f32_16x16x32_bf16 v[64:67], v[152:155], a[16:19], v[64:67]
    buffer_load_dwordx4 v2, s[32:35], s44 offen offset:1024 sc1 lds
    v_mfma_f32_16x16x32_bf16 v[68:71], v[152:155], a[20:23], v[68:71]
    v_mfma_f32_16x16x32_bf16 v[76:79], v[156:159], a[20:23], v[76:79]
    ds_read_b128 v[176:179], v11 offset:32768
    ds_read_b128 v[180:183], v11 offset:33024
    v_mfma_f32_16x16x32_bf16 v[72:75], v[156:159], a[16:19], v[72:75]
    s_waitcnt vmcnt(18)
    v_mfma_f32_16x16x32_bf16 v[112:115], v[152:155], a[24:27], v[112:115]
    s_waitcnt vmcnt(17)
    v_mfma_f32_16x16x32_bf16 v[116:119], v[152:155], a[28:31], v[116:119]
    s_waitcnt vmcnt(8)
    v_cmp_gt_u32 vcc, 1, v5
    s_nop 0
    s_and_b64 vcc, vcc, 0xff
    s_cbranch_scc1 L_o_27
L_r_28:
    s_add_u32 s4, s4, 128
    s_add_u32 s5, s5, 128
    v_mfma_f32_16x16x32_bf16 v[124:127], v[156:159], a[28:31], v[124:127]
    s_add_u32 s68, s81, 6144
    buffer_load_dwordx4 a[64:67], v15, s[32:35], s68 offen sc1
    v_mfma_f32_16x16x32_bf16 v[120:123], v[156:159], a[24:27], v[120:123]
    v_mfma_f32_16x16x32_bf16 v[96:99], v[144:147], a[24:27], v[96:99]
    buffer_load_dwordx4 a[68:71], v15, s[32:35], s68 offen offset:256 sc1
    v_mfma_f32_16x16x32_bf16 v[100:103], v[144:147], a[28:31], v[100:103]
    v_mfma_f32_16x16x32_bf16 v[108:111], v[148:151], a[28:31], v[108:111]
    s_add_u32 s68, s81, 6144
    buffer_load_dwordx4 a[72:75], v42, s[32:35], s68 offen sc1
    v_mfma_f32_16x16x32_bf16 v[104:107], v[148:151], a[24:27], v[104:107]
    s_waitcnt lgkmcnt(2)
    v_mfma_f32_16x16x32_bf16 v[48:51], v[168:171], a[32:35], v[48:51]
    buffer_load_dwordx4 a[76:79], v42, s[32:35], s68 offen offset:256 sc1
    v_mfma_f32_16x16x32_bf16 v[52:55], v[168:171], a[36:39], v[52:55]
    v_mfma_f32_16x16x32_bf16 v[60:63], v[172:175], a[36:39], v[60:63]
    ds_read_b128 v[184:187], v10 offset:36864
    ds_read_b128 v[188:191], v10 offset:37120
    v_mfma_f32_16x16x32_bf16 v[56:59], v[172:175], a[32:35], v[56:59]
    s_add_u32 s68, s81, 38912
    buffer_load_dwordx4 a[80:83], v15, s[32:35], s68 offen sc1
    s_waitcnt lgkmcnt(2)
    v_mfma_f32_16x16x32_bf16 v[64:67], v[176:179], a[32:35], v[64:67]
    buffer_load_dwordx4 a[84:87], v15, s[32:35], s68 offen offset:256 sc1
    v_mfma_f32_16x16x32_bf16 v[68:71], v[176:179], a[36:39], v[68:71]
    v_mfma_f32_16x16x32_bf16 v[76:79], v[180:183], a[36:39], v[76:79]
    ds_read_b128 v[192:195], v11 offset:36864
    ds_read_b128 v[196:199], v11 offset:37120
    v_mfma_f32_16x16x32_bf16 v[72:75], v[180:183], a[32:35], v[72:75]
    s_add_u32 s68, s81, 38912
    buffer_load_dwordx4 a[88:91], v42, s[32:35], s68 offen sc1
    v_mfma_f32_16x16x32_bf16 v[112:115], v[176:179], a[40:43], v[112:115]
    buffer_load_dwordx4 a[92:95], v42, s[32:35], s68 offen offset:256 sc1
    v_mfma_f32_16x16x32_bf16 v[116:119], v[176:179], a[44:47], v[116:119]
    v_mfma_f32_16x16x32_bf16 v[124:127], v[180:183], a[44:47], v[124:127]
    v_mfma_f32_16x16x32_bf16 v[120:123], v[180:183], a[40:43], v[120:123]
    v_mfma_f32_16x16x32_bf16 v[96:99], v[168:171], a[40:43], v[96:99]
    v_mfma_f32_16x16x32_bf16 v[100:103], v[168:171], a[44:47], v[100:103]
    v_mfma_f32_16x16x32_bf16 v[108:111], v[172:175], a[44:47], v[108:111]
    v_mfma_f32_16x16x32_bf16 v[104:107], v[172:175], a[40:43], v[104:107]
    s_waitcnt lgkmcnt(2)
    v_mfma_f32_16x16x32_bf16 v[48:51], v[184:187], a[48:51], v[48:51]
    s_waitcnt vmcnt(8)
    ds_read_b128 v[128:131], v12 offset:0
    v_mfma_f32_16x16x32_bf16 v[52:55], v[184:187], a[52:55], v[52:55]
    ds_read_b128 v[132:135], v12 offset:256
    v_mfma_f32_16x16x32_bf16 v[60:63], v[188:191], a[52:55], v[60:63]
    ds_read_b128 v[136:139], v13 offset:0
    ds_read_b128 v[140:143], v13 offset:256
    v_mfma_f32_16x16x32_bf16 v[56:59], v[188:191], a[48:51], v[56:59]
    s_waitcnt lgkmcnt(4)
    v_mfma_f32_16x16x32_bf16 v[64:67], v[192:195], a[48:51], v[64:67]
    ds_read_b128 v[144:147], v12 offset:4096
    ds_read_b128 v[148:151], v12 offset:4352
    v_mfma_f32_16x16x32_bf16 v[68:71], v[192:195], a[52:55], v[68:71]
    v_mfma_f32_16x16x32_bf16 v[76:79], v[196:199], a[52:55], v[76:79]
    ds_read_b128 v[152:155], v13 offset:4096
    ds_read_b128 v[156:159], v13 offset:4352
    v_mfma_f32_16x16x32_bf16 v[72:75], v[196:199], a[48:51], v[72:75]
    v_mfma_f32_16x16x32_bf16 v[112:115], v[192:195], a[56:59], v[112:115]
    v_mfma_f32_16x16x32_bf16 v[116:119], v[192:195], a[60:63], v[116:119]
    v_mfma_f32_16x16x32_bf16 v[124:127], v[196:199], a[60:63], v[124:127]
    v_mfma_f32_16x16x32_bf16 v[120:123], v[196:199], a[56:59], v[120:123]
    v_mfma_f32_16x16x32_bf16 v[96:99], v[184:187], a[56:59], v[96:99]
    v_mfma_f32_16x16x32_bf16 v[100:103], v[184:187], a[60:63], v[100:103]
    v_mfma_f32_16x16x32_bf16 v[108:111], v[188:191], a[60:63], v[108:111]
    v_mfma_f32_16x16x32_bf16 v[104:107], v[188:191], a[56:59], v[104:107]
    s_waitcnt vmcnt(7) lgkmcnt(4)
    v_mfma_f32_16x16x32_bf16 v[64:67], v[136:139], a[64:67], v[64:67]
    s_waitcnt vmcnt(6)
    v_mfma_f32_16x16x32_bf16 v[68:71], v[136:139], a[68:71], v[68:71]
    v_mfma_f32_16x16x32_bf16 v[76:79], v[140:143], a[68:71], v[76:79]
    v_mfma_f32_16x16x32_bf16 v[72:75], v[140:143], a[64:67], v[72:75]
    s_waitcnt vmcnt(3) lgkmcnt(1)
    v_mfma_f32_16x16x32_bf16 v[64:67], v[152:155], a[80:83], v[64:67]
    s_waitcnt vmcnt(2)
    v_mfma_f32_16x16x32_bf16 v[68:71], v[152:155], a[84:87], v[68:71]
    s_waitcnt lgkmcnt(0)
    v_mfma_f32_16x16x32_bf16 v[76:79], v[156:159], a[84:87], v[76:79]
    v_mfma_f32_16x16x32_bf16 v[72:75], v[156:159], a[80:83], v[72:75]
    v_mfma_f32_16x16x32_bf16 v[112:115], v[136:139], a[72:75], v[112:115]
    v_mfma_f32_16x16x32_bf16 v[116:119], v[136:139], a[76:79], v[116:119]
    v_mfma_f32_16x16x32_bf16 v[124:127], v[140:143], a[76:79], v[124:127]
    ds_write_b128 v37, v[64:67] offset:0
    v_mfma_f32_16x16x32_bf16 v[120:123], v[140:143], a[72:75], v[120:123]
    s_waitcnt vmcnt(1)
    v_mfma_f32_16x16x32_bf16 v[112:115], v[152:155], a[88:91], v[112:115]
    ds_write_b128 v37, v[68:71] offset:1024
    s_waitcnt vmcnt(0)
    v_mfma_f32_16x16x32_bf16 v[116:119], v[152:155], a[92:95], v[116:119]
    v_mfma_f32_16x16x32_bf16 v[124:127], v[156:159], a[92:95], v[124:127]
    ds_write_b128 v37, v[72:75] offset:2048
    v_mfma_f32_16x16x32_bf16 v[120:123], v[156:159], a[88:91], v[120:123]
    v_mfma_f32_16x16x32_bf16 v[96:99], v[128:131], a[72:75], v[96:99]
    ds_write_b128 v37, v[76:79] offset:3072
    v_mfma_f32_16x16x32_bf16 v[100:103], v[128:131], a[76:79], v[100:103]
    v_mfma_f32_16x16x32_bf16 v[108:111], v[132:135], a[76:79], v[108:111]
    ds_write_b128 v39, v[112:115] offset:8192
    v_mfma_f32_16x16x32_bf16 v[104:107], v[132:135], a[72:75], v[104:107]
    v_mfma_f32_16x16x32_bf16 v[96:99], v[144:147], a[88:91], v[96:99]
    ds_write_b128 v39, v[116:119] offset:9216
    v_mfma_f32_16x16x32_bf16 v[100:103], v[144:147], a[92:95], v[100:103]
    v_mfma_f32_16x16x32_bf16 v[108:111], v[148:151], a[92:95], v[108:111]
    ds_write_b128 v39, v[120:123] offset:10240
    v_mfma_f32_16x16x32_bf16 v[104:107], v[148:151], a[88:91], v[104:107]
    v_mfma_f32_16x16x32_bf16 v[48:51], v[128:131], a[64:67], v[48:51]
    ds_write_b128 v39, v[124:127] offset:11264
    v_mfma_f32_16x16x32_bf16 v[52:55], v[128:131], a[68:71], v[52:55]
    v_mfma_f32_16x16x32_bf16 v[60:63], v[132:135], a[68:71], v[60:63]
    ds_write_b128 v38, v[96:99] offset:4096
    ds_write_b128 v38, v[100:103] offset:5120
    v_mfma_f32_16x16x32_bf16 v[56:59], v[132:135], a[64:67], v[56:59]
    v_mfma_f32_16x16x32_bf16 v[48:51], v[144:147], a[80:83], v[48:51]
    ds_write_b128 v38, v[104:107] offset:6144
    v_mfma_f32_16x16x32_bf16 v[52:55], v[144:147], a[84:87], v[52:55]
    v_mfma_f32_16x16x32_bf16 v[60:63], v[148:151], a[84:87], v[60:63]
    ds_write_b128 v38, v[108:111] offset:7168
    v_mfma_f32_16x16x32_bf16 v[56:59], v[148:151], a[80:83], v[56:59]
    s_waitcnt lgkmcnt(0)
    s_barrier
    ds_read_b128 v[160:163], v36 offset:0
    ds_read_b128 v[176:179], v36 offset:4096
    ds_read_b128 v[192:195], v36 offset:8192
    ds_read_b128 v[164:167], v36 offset:1024
    ds_read_b128 v[180:183], v36 offset:5120
    ds_read_b128 v[196:199], v36 offset:9216
    ds_read_b128 v[168:171], v36 offset:2048
    ds_read_b128 v[184:187], v36 offset:6144
    ds_read_b128 v[200:203], v36 offset:10240
    ds_read_b128 v[172:175], v36 offset:3072
    ds_read_b128 v[188:191], v36 offset:7168
    ds_read_b128 v[204:207], v36 offset:11264
    s_waitcnt lgkmcnt(11)
    v_pk_add_f32 v[48:49], v[48:49], v[160:161]
    s_waitcnt lgkmcnt(9)
    v_pk_add_f32 v[176:177], v[176:177], v[192:193]
    v_pk_add_f32 v[50:51], v[50:51], v[162:163]
    v_pk_add_f32 v[178:179], v[178:179], v[194:195]
    v_pk_add_f32 v[48:49], v[48:49], v[176:177]
    v_pk_add_f32 v[50:51], v[50:51], v[178:179]
    v_cvt_pk_bf16_f32 v112, v48, v49
    v_cvt_pk_bf16_f32 v113, v50, v51
    s_waitcnt lgkmcnt(8)
    v_pk_add_f32 v[52:53], v[52:53], v[164:165]
    s_waitcnt lgkmcnt(6)
    v_pk_add_f32 v[180:181], v[180:181], v[196:197]
    v_pk_add_f32 v[54:55], v[54:55], v[166:167]
    v_pk_add_f32 v[182:183], v[182:183], v[198:199]
    v_pk_add_f32 v[52:53], v[52:53], v[180:181]
    v_pk_add_f32 v[54:55], v[54:55], v[182:183]
    v_cvt_pk_bf16_f32 v114, v52, v53
    v_cvt_pk_bf16_f32 v115, v54, v55
    s_nop 0
    v_permlane16_swap_b32 v112, v114
    v_permlane16_swap_b32 v113, v115
    buffer_store_dwordx4 v[112:115], v233, s[28:31], s82 offen offset:0
    s_waitcnt lgkmcnt(5)
    v_pk_add_f32 v[56:57], v[56:57], v[168:169]
    s_waitcnt lgkmcnt(3)
    v_pk_add_f32 v[184:185], v[184:185], v[200:201]
    v_pk_add_f32 v[58:59], v[58:59], v[170:171]
    v_pk_add_f32 v[186:187], v[186:187], v[202:203]
    v_pk_add_f32 v[56:57], v[56:57], v[184:185]
    v_pk_add_f32 v[58:59], v[58:59], v[186:187]
    v_cvt_pk_bf16_f32 v116, v56, v57
    v_cvt_pk_bf16_f32 v117, v58, v59
    s_waitcnt lgkmcnt(2)
    v_pk_add_f32 v[60:61], v[60:61], v[172:173]
    s_waitcnt lgkmcnt(0)
    v_pk_add_f32 v[188:189], v[188:189], v[204:205]
    v_pk_add_f32 v[62:63], v[62:63], v[174:175]
    v_pk_add_f32 v[190:191], v[190:191], v[206:207]
    v_pk_add_f32 v[60:61], v[60:61], v[188:189]
    v_pk_add_f32 v[62:63], v[62:63], v[190:191]
    v_cvt_pk_bf16_f32 v118, v60, v61
    v_cvt_pk_bf16_f32 v119, v62, v63
    s_nop 0
    v_permlane16_swap_b32 v116, v118
    v_permlane16_swap_b32 v117, v119
    buffer_store_dwordx4 v[116:119], v233, s[28:31], s82 offen offset:32
L_end:
    s_endpgm
L_o_3:
    buffer_atomic_add v46, v245, s[36:39], 0 offen sc1
    s_branch L_r_4
L_o_6:
    s_mov_b32 s59, 0
    s_mov_b64 exec, 1
L_pl_5:
    buffer_load_dword v5, off, s[36:39], 0 sc1
    s_add_u32 s59, s59, 1
    s_waitcnt vmcnt(0)
    v_and_b32 v43, 63, v5
    v_cmp_gt_u32 vcc, 32, v43
    s_cmp_ge_u32 s59, 0x8000
    s_nop 0
    s_cselect_b64 vcc, 0, vcc
    s_nop 0
    s_and_b64 exec, exec, vcc
    s_cbranch_scc1 L_pl_5
    s_mov_b64 exec, -1
    s_branch L_r_7
L_o_11:
    s_mov_b32 s59, 0
    s_mov_b64 exec, 0xffff
L_pl_10:
    buffer_load_dword v5, v236, s[32:35], s21 offen sc1
    s_add_u32 s59, s59, 1
    s_waitcnt vmcnt(0)
    v_cmp_gt_u32 vcc, 16, v5
    s_cmp_ge_u32 s59, 0x8000
    s_nop 0
    s_cselect_b64 vcc, 0, vcc
    s_nop 0
    s_and_b64 exec, exec, vcc
    s_cbranch_scc1 L_pl_10
    s_mov_b64 exec, -1
    s_branch L_r_12
L_o_15:
    s_mov_b32 s59, 0
    s_mov_b64 exec, 0xffff
L_pl_14:
    buffer_load_dword v5, v236, s[32:35], s21 offen sc1
    s_add_u32 s59, s59, 1
    s_waitcnt vmcnt(0)
    v_cmp_gt_u32 vcc, 16, v5
    s_cmp_ge_u32 s59, 0x8000
    s_nop 0
    s_cselect_b64 vcc, 0, vcc
    s_nop 0
    s_and_b64 exec, exec, vcc
    s_cbranch_scc1 L_pl_14
    s_mov_b64 exec, -1
    s_branch L_r_16
L_o_18:
    s_mov_b32 s59, 0
    s_mov_b64 exec, 0xff
L_pl_17:
    buffer_load_dword v5, v247, s[32:35], s4 offen sc1
    s_add_u32 s59, s59, 1
    s_waitcnt vmcnt(0)
    v_cmp_gt_u32 vcc, 1, v5
    s_cmp_ge_u32 s59, 0x8000
    s_nop 0
    s_cselect_b64 vcc, 0, vcc
    s_nop 0
    s_and_b64 exec, exec, vcc
    s_cbranch_scc1 L_pl_17
    s_mov_b64 exec, -1
    s_branch L_r_19
L_o_21:
    s_mov_b32 s59, 0
    s_mov_b64 exec, 0xff
L_pl_20:
    buffer_load_dword v5, v247, s[32:35], s4 offen sc1
    s_add_u32 s59, s59, 1
    s_waitcnt vmcnt(0)
    v_cmp_gt_u32 vcc, 1, v5
    s_cmp_ge_u32 s59, 0x8000
    s_nop 0
    s_cselect_b64 vcc, 0, vcc
    s_nop 0
    s_and_b64 exec, exec, vcc
    s_cbranch_scc1 L_pl_20
    s_mov_b64 exec, -1
    s_branch L_r_22
L_o_24:
    s_mov_b32 s59, 0
    s_mov_b64 exec, 0xff
L_pl_23:
    buffer_load_dword v5, v247, s[32:35], s4 offen sc1
    s_add_u32 s59, s59, 1
    s_waitcnt vmcnt(0)
    v_cmp_gt_u32 vcc, 1, v5
    s_cmp_ge_u32 s59, 0x8000
    s_nop 0
    s_cselect_b64 vcc, 0, vcc
    s_nop 0
    s_and_b64 exec, exec, vcc
    s_cbranch_scc1 L_pl_23
    s_mov_b64 exec, -1
    s_branch L_r_25
L_o_27:
    s_mov_b32 s59, 0
    s_mov_b64 exec, 0xff
L_pl_26:
    buffer_load_dword v5, v247, s[32:35], s4 offen sc1
    s_add_u32 s59, s59, 1
    s_waitcnt vmcnt(0)
    v_cmp_gt_u32 vcc, 1, v5
    s_cmp_ge_u32 s59, 0x8000
    s_nop 0
    s_cselect_b64 vcc, 0, vcc
    s_nop 0
    s_and_b64 exec, exec, vcc
    s_cbranch_scc1 L_pl_26
    s_mov_b64 exec, -1
    s_branch L_r_28
.section .rodata,"a"
.p2align 6
.amdhsa_kernel sequential_preLN__linear_attn_block__glu_gated_swiglu__prompt_kernel
  .amdhsa_next_free_vgpr 512
  .amdhsa_next_free_sgpr 102
  .amdhsa_accum_offset 256
  .amdhsa_group_segment_fixed_size 0
  .amdhsa_kernarg_size 80
  .amdhsa_user_sgpr_count 2
  .amdhsa_user_sgpr_kernarg_segment_ptr 1
  .amdhsa_system_sgpr_workgroup_id_x 1
.end_amdhsa_kernel
```
